```python
import torch

def _softmax(x, axis=-1):
    return torch.softmax(x, dim=axis)
def _gelu(x):
    return torch.nn.functional.gelu(x, approximate="tanh")
def _silu(x):
    return torch.nn.functional.silu(x)
def _sigmoid(x):
    return torch.sigmoid(x)
def _layernorm(x, axis=-1, eps=1e-5):
    m = x.mean(dim=axis, keepdim=True)
    v = x.var(dim=axis, keepdim=True, unbiased=False)
    return (x - m) / torch.sqrt(v + eps)
def _scatter_add(tgt, idx, src, axis=0):
    return tgt.clone().index_add_(axis, idx, src)
def _segment_sum(src, seg, n):
    out = torch.zeros((n,) + src.shape[1:], dtype=src.dtype)
    return out.index_add_(0, seg, src)
def _pad(x, pw):
    flat = tuple(v for pair in reversed(pw) for v in pair)
    return torch.nn.functional.pad(x, flat)

kernel_name = 'gather_scatter__cheap_equivariant_egnn__graph'

def setup_inputs():

    _w = (lambda a: (lambda t: t.to(torch.bfloat16) if t.is_floating_point() else t)(torch.as_tensor(a)))
    N, deg, D, De = 25000, 32, 64, max(16, 1)
    E = N * deg
    return {
        "h": _w((lambda *s: torch.randn(*s, dtype=torch.bfloat16) * 0.2)(N, D)),
        "pos": _w((lambda *s: torch.randn(*s, dtype=torch.bfloat16) * 0.8)(N, 3)),
        "e_attr": _w((lambda *s: torch.randn(*s, dtype=torch.bfloat16) * 0.8)(E, De)),
        "src": _w((lambda lo, hi, *s: torch.randint(lo, hi, s))(0, N, E).to(torch.int64)),
        "dst": _w((lambda lo, hi, *s: torch.randint(lo, hi, s))(0, N, E).to(torch.int64)),
        "w_e": _w(0.1 * (lambda *s: torch.randn(*s, dtype=torch.bfloat16) * 0.8)(2 * D + 1 + De, D)),
        "w_x": _w(0.1 * (lambda *s: torch.randn(*s, dtype=torch.bfloat16) * 0.2)(D, 1)),
        "w_h": _w(0.1 * (lambda *s: torch.randn(*s, dtype=torch.bfloat16) * 0.2)(2 * D, D)),
    }

def reference(h, pos, e_attr, src, dst, w_e, w_x, w_h):
    N, D = h.shape[0], h.shape[1]
    diff = pos[dst] - pos[src]
    dist2 = torch.sum(diff * diff, axis=-1, keepdims=True)
    e_in = torch.concatenate([h[dst], h[src], dist2, e_attr], axis=-1)
    m_ij = _silu(e_in @ w_e)
    coord_scale = m_ij @ w_x
    pos_new = pos + _segment_sum(diff * coord_scale, dst, N)
    m_i = _segment_sum(m_ij, dst, N)
    h_new = h + _silu(torch.concatenate([h, m_i], axis=-1) @ w_h)
    return h_new, pos_new
```

```asm
; @launch grid=(256,1,1) block=(512,1,1) lds=163840
.amdgcn_target "amdgcn-amd-amdhsa--gfx950"
.text
.globl gather_scatter__cheap_equivariant_egnn__graph_kernel
.p2align 8
.type gather_scatter__cheap_equivariant_egnn__graph_kernel,@function
gather_scatter__cheap_equivariant_egnn__graph_kernel:
    s_cmp_ge_u32 s2, 256
    s_cbranch_scc1 L_end
    s_load_dwordx2 s[48:49], s[0:1], 32
    s_load_dwordx2 s[44:45], s[0:1], 24
    s_load_dwordx2 s[36:37], s[0:1], 40
    s_load_dwordx2 s[28:29], s[0:1], 80
    s_load_dwordx2 s[20:21], s[0:1], 8
    s_load_dwordx2 s[16:17], s[0:1], 0
    s_load_dwordx2 s[56:57], s[0:1], 72
    s_load_dwordx2 s[24:25], s[0:1], 16
    s_load_dwordx2 s[32:33], s[0:1], 64
    s_load_dwordx2 s[40:41], s[0:1], 48
    s_load_dwordx2 s[52:53], s[0:1], 56
    v_lshrrev_b32 v1, 6, v0
    v_and_b32 v12, 63, v0
    v_readfirstlane_b32 s3, v1
    v_mov_b32 v13, v0
    v_lshlrev_b32 v16, 4, v12
    v_lshlrev_b32 v17, 4, v0
    s_mul_i32 s68, s2, 12500
    s_add_u32 s69, s68, 8192
    s_and_b32 s60, s2, 7
    s_lshl_b32 s60, s60, 5
    s_lshr_b32 s4, s2, 3
    s_add_u32 s60, s60, s4
    s_mul_i32 s61, s60, 98
    s_mul_i32 s76, s61, 6
    v_cmp_gt_u32 vcc, 270, v0
    v_mov_b32 v18, 2147483616
    v_mov_b32 v0, 0
    v_cndmask_b32 v18, v18, v17, vcc
    s_waitcnt lgkmcnt(0)
    s_and_b32 s49, s49, 0xffff
    s_mov_b32 s50, 3200000
    s_mov_b32 s51, 0x20000
    s_and_b32 s45, s45, 0xffff
    s_mov_b32 s46, 3200000
    s_mov_b32 s47, 0x20000
    s_and_b32 s29, s29, 0xffff
    s_mov_b32 s30, 268435456
    s_mov_b32 s31, 0x20000
    s_xor_b32 s87, s3, 7
    s_or_b32 s87, s87, s2
    s_cmp_lg_u32 s87, 0
    s_cbranch_scc1 L_noepoch0
    buffer_load_dwordx2 v[64:65], v0, s[28:31], 0 offen sc0 sc1
L_noepoch0:
    buffer_load_dwordx4 v[20:23], v17, s[48:51], s68 offen nt
    buffer_load_dwordx4 v[24:27], v18, s[48:51], s69 offen nt
    buffer_load_dwordx4 v[28:31], v17, s[44:47], s68 offen nt
    buffer_load_dwordx4 v[32:35], v18, s[44:47], s69 offen nt
    s_and_b32 s37, s37, 0xffff
    s_mov_b32 s38, 18560
    s_mov_b32 s39, 0x20000
    s_and_b32 s21, s21, 0xffff
    s_mov_b32 s22, 150000
    s_mov_b32 s23, 0x20000
    s_and_b32 s17, s17, 0xffff
    s_mov_b32 s18, 3200000
    s_mov_b32 s19, 0x20000
    s_and_b32 s57, s57, 0xffff
    s_mov_b32 s58, 256
    s_mov_b32 s59, 0x20000
    s_and_b32 s25, s25, 0xffff
    s_mov_b32 s26, 25600000
    s_mov_b32 s27, 0x20000
    s_and_b32 s33, s33, 0xffff
    s_mov_b32 s34, 3350000
    s_mov_b32 s35, 0x20000
    s_and_b32 s41, s41, 0xffff
    s_mov_b32 s42, 128
    s_mov_b32 s43, 0x20000
    s_and_b32 s53, s53, 0xffff
    s_mov_b32 s54, 16384
    s_mov_b32 s55, 0x20000
    s_sub_u32 s62, 25000, s61
    s_min_u32 s62, s62, 98
    s_mov_b32 s63, 0
    s_mov_b32 s64, 256
    s_mov_b32 s65, 0
    s_mov_b32 s70, 128
    s_mov_b32 s71, 0xffffffe0
    s_mov_b32 s72, 161920
    s_mov_b32 s77, 162816
    s_mov_b32 s75, 0xbfb8aa3b
    s_mov_b32 s8, 0
    s_mov_b32 s9, -1
    s_mov_b32 s10, -1
    s_mov_b32 s11, 0
    s_lshl_b32 s67, s3, 12
    s_cmp_lg_u32 s3, 2
    s_cbranch_scc1 L_noinit0
    v_lshrrev_b32 v60, 2, v12
    v_and_b32 v61, 3, v12
    v_lshrrev_b32 v62, 1, v60
    v_cmp_eq_u32 vcc, v61, v62
    v_and_b32 v62, 1, v60
    v_lshlrev_b32 v62, 4, v62
    v_mov_b32 v63, 0x3f80
    v_lshlrev_b32 v62, v62, v63
    v_cndmask_b32 v62, 0, v62, vcc
    v_cmp_gt_u32 vcc, 7, v60
    v_lshlrev_b32 v61, 2, v12
    v_add_u32 v61, 161792, v61
    v_cndmask_b32 v62, 0, v62, vcc
    v_min_u32 v63, 2, v12
    v_lshlrev_b32 v63, 7, v63
    v_lshl_add_u32 v63, v12, 10, v63
    v_cmp_gt_u32 vcc, 16, v12
    v_add_u32 v63, 65536, v63
    s_nop 0
    v_cndmask_b32 v63, 0, v63, vcc
    s_mov_b64 exec, 0xffffffff
    ds_write_b32 v61, v63
    ds_write_b32 v61, v62 offset:128
    s_mov_b64 exec, -1
L_noinit0:
    s_cmp_lg_u32 s3, 1
    s_cbranch_scc1 L_nocnt
    v_mov_b32 v60, 0
    v_mov_b32 v61, 0
    v_mov_b32 v62, 0
    v_mov_b32 v63, 0
    ds_write_b128 v16, v[60:63] offset:20480
L_nocnt:
    v_lshrrev_b32 v9, 5, v12
    v_lshlrev_b32 v9, 4, v9
    v_lshrrev_b32 v60, 4, v12
    v_and_b32 v61, 7, v12
    v_xor_b32 v60, v60, v61
    v_lshlrev_b32 v1, 4, v60
    v_xor_b32 v2, 64, v1
    v_and_b32 v60, 31, v12
    v_bfe_u32 v61, v60, 1, 3
    v_lshlrev_b32 v61, 4, v61
    v_xor_b32 v61, v61, v9
    v_lshl_add_u32 v61, v60, 7, v61
    v_add_u32 v3, s67, v61
    v_xor_b32 v4, 32, v3
    v_xor_b32 v5, 64, v3
    v_xor_b32 v6, 96, v3
    s_lshl_b32 s68, s3, 11
    s_add_u32 s68, s68, 115712
    v_lshl_add_u32 v7, v60, 6, s68
    v_bfe_u32 v61, v12, 4, 1
    v_and_b32 v62, 3, v12
    v_lshlrev_b32 v62, 3, v62
    v_lshl_add_u32 v62, v61, 5, v62
    v_bfe_u32 v61, v12, 2, 2
    v_lshl_add_u32 v63, v61, 6, v62
    v_lshl_add_u32 v63, v9, 4, v63
    v_add_u32 v8, s68, v63
    v_lshl_add_u32 v63, v61, 7, v62
    v_lshl_add_u32 v76, v9, 6, v63
    v_lshrrev_b32 v10, 3, v12
    v_lshlrev_b32 v10, 4, v10
    v_and_b32 v61, 7, v12
    v_bfe_u32 v62, v12, 3, 2
    v_lshl_add_u32 v61, v61, 2, v62
    v_lshlrev_b32 v11, 2, v61
    v_mov_b32 v168, 0
    v_mov_b32 v169, 0
    v_mov_b32 v170, 0
    v_mov_b32 v171, 0
    v_mov_b32 v172, 0
    v_mov_b32 v173, 0
    v_mov_b32 v174, 0
    v_mov_b32 v175, 0
    v_mov_b32 v176, 0
    v_mov_b32 v177, 0
    v_mov_b32 v178, 0
    v_mov_b32 v179, 0
    v_mov_b32 v180, 0
    v_mov_b32 v181, 0
    v_mov_b32 v182, 0
    v_mov_b32 v183, 0
    v_mov_b32 v184, 0
    v_mov_b32 v185, 0
    v_mov_b32 v186, 0
    v_mov_b32 v187, 0
    v_mov_b32 v188, 0
    v_mov_b32 v189, 0
    v_mov_b32 v190, 0
    v_mov_b32 v191, 0
    v_mov_b32 v192, 0
    v_mov_b32 v193, 0
    v_mov_b32 v194, 0
    v_mov_b32 v195, 0
    v_mov_b32 v196, 0
    v_mov_b32 v197, 0
    v_mov_b32 v198, 0
    v_mov_b32 v199, 0
    v_mov_b32 v200, 0
    v_mov_b32 v201, 0
    v_mov_b32 v202, 0
    v_mov_b32 v203, 0
    v_mov_b32 v204, 0
    v_mov_b32 v205, 0
    v_mov_b32 v206, 0
    v_mov_b32 v207, 0
    v_mov_b32 v208, 0
    v_mov_b32 v209, 0
    v_mov_b32 v210, 0
    v_mov_b32 v211, 0
    v_mov_b32 v212, 0
    v_mov_b32 v213, 0
    v_mov_b32 v214, 0
    v_mov_b32 v215, 0
    v_mov_b32 v216, 0
    v_mov_b32 v217, 0
    v_mov_b32 v218, 0
    v_mov_b32 v219, 0
    v_mov_b32 v220, 0
    v_mov_b32 v221, 0
    v_mov_b32 v222, 0
    v_mov_b32 v223, 0
    v_mov_b32 v224, 0
    v_mov_b32 v225, 0
    v_mov_b32 v226, 0
    v_mov_b32 v227, 0
    v_mov_b32 v228, 0
    v_mov_b32 v229, 0
    v_mov_b32 v230, 0
    v_mov_b32 v231, 0
    v_mov_b32 v60, 270
    v_cmp_gt_u32 s[4:5], v60, v13
    v_mov_b32 v60, 269
    v_cmp_gt_u32 s[6:7], v60, v13
    s_mov_b32 s68, 42800
    s_mov_b32 s69, -98
    v_mov_b32 v59, 1
    v_lshlrev_b32 v60, 7, v13
    s_cmp_lg_u32 s87, 0
    s_cbranch_scc1 L_noepoch
    s_mov_b64 exec, 1
    s_waitcnt vmcnt(4)
    v_add_u32 v64, 1, v64
    v_and_b32 v67, 0x3ff, v65
    v_mov_b32 v66, v64
    v_or_b32 v67, 0x80000000, v67
    buffer_store_dwordx2 v[66:67], v0, s[56:59], 0 offen sc0 sc1
    buffer_store_dword v64, v0, s[28:31], 0 offen sc0 sc1
    s_mov_b64 exec, -1
L_noepoch:
    s_mov_b32 s87, 0
    s_waitcnt lgkmcnt(0)
    s_barrier
    s_waitcnt vmcnt(2)
    v_mul_u32_u24 v36, s68, v20
    v_lshrrev_b32 v36, 22, v36
    v_mad_i32_i24 v20, v36, s69, v20
    v_lshlrev_b32 v36, 2, v36
    ds_add_rtn_u32 v44, v36, v59 offset:20480
    v_mul_u32_u24 v37, s68, v21
    v_lshrrev_b32 v37, 22, v37
    v_mad_i32_i24 v21, v37, s69, v21
    v_lshlrev_b32 v37, 2, v37
    ds_add_rtn_u32 v45, v37, v59 offset:20480
    v_mul_u32_u24 v38, s68, v22
    v_lshrrev_b32 v38, 22, v38
    v_mad_i32_i24 v22, v38, s69, v22
    v_lshlrev_b32 v38, 2, v38
    ds_add_rtn_u32 v46, v38, v59 offset:20480
    v_mul_u32_u24 v39, s68, v23
    v_lshrrev_b32 v39, 22, v39
    v_mad_i32_i24 v23, v39, s69, v23
    v_lshlrev_b32 v39, 2, v39
    ds_add_rtn_u32 v47, v39, v59 offset:20480
    v_mul_u32_u24 v40, s68, v24
    v_lshrrev_b32 v40, 22, v40
    v_mad_i32_i24 v24, v40, s69, v24
    v_lshlrev_b32 v40, 2, v40
    s_mov_b64 exec, s[4:5]
    ds_add_rtn_u32 v48, v40, v59 offset:20480
    v_mul_u32_u24 v41, s68, v25
    v_lshrrev_b32 v41, 22, v41
    v_mad_i32_i24 v25, v41, s69, v25
    v_lshlrev_b32 v41, 2, v41
    s_mov_b64 exec, s[6:7]
    ds_add_rtn_u32 v49, v41, v59 offset:20480
    v_mul_u32_u24 v42, s68, v26
    v_lshrrev_b32 v42, 22, v42
    v_mad_i32_i24 v26, v42, s69, v26
    v_lshlrev_b32 v42, 2, v42
    ds_add_rtn_u32 v50, v42, v59 offset:20480
    v_mul_u32_u24 v43, s68, v27
    v_lshrrev_b32 v43, 22, v43
    v_mad_i32_i24 v27, v43, s69, v27
    v_lshlrev_b32 v43, 2, v43
    ds_add_rtn_u32 v51, v43, v59 offset:20480
    s_mov_b64 exec, -1
    s_lshl_b32 s82, s3, 10
    s_add_u32 m0, s82, 150528
    s_add_u32 s83, s82, 8192
    buffer_load_dwordx4 v16, s[36:39], s83 offen lds
    s_cmp_lt_u32 s3, 3
    s_cbranch_scc0 L_now2b
    s_add_u32 m0, s82, 158720
    s_add_u32 s83, s82, 16384
    buffer_load_dwordx4 v16, s[36:39], s83 offen lds
    s_branch L_w2b
L_now2b:
    v_mov_b32 v52, 2147483616
    buffer_load_dword v52, v52, s[36:39], 0 offen
L_w2b:
    v_mad_u32_u24 v53, v13, 6, s76
    v_mov_b32 v57, 2147483616
    v_cmp_gt_u32 vcc, 98, v13
    s_lshr_b32 s74, s2, 3
    s_mul_i32 s74, s74, 100096
    v_cndmask_b32 v53, v57, v53, vcc
    buffer_load_ushort v54, v53, s[20:23], 0 offen offset:0
    buffer_load_ushort v55, v53, s[20:23], 0 offen offset:2
    buffer_load_ushort v56, v53, s[20:23], 0 offen offset:4
    v_lshl_add_u32 v58, v12, 3, s3
    v_cmp_gt_u32 vcc, 160, v58
    v_lshlrev_b32 v58, 7, v58
    s_nop 0
    v_cndmask_b32 v58, v57, v58, vcc
    buffer_load_dword v77, v58, s[16:19], s74 offen
    s_waitcnt vmcnt(6)
    v_lshl_or_b32 v28, v28, 17, v60
    v_lshrrev_b32 v61, 2, v20
    v_and_or_b32 v28, v61, 28, v28
    v_add_u32 v60, 32, v60
    v_lshl_or_b32 v29, v29, 17, v60
    v_lshrrev_b32 v61, 2, v21
    v_and_or_b32 v29, v61, 28, v29
    v_add_u32 v60, 32, v60
    v_lshl_or_b32 v30, v30, 17, v60
    v_lshrrev_b32 v61, 2, v22
    v_and_or_b32 v30, v61, 28, v30
    v_add_u32 v60, 32, v60
    v_lshl_or_b32 v31, v31, 17, v60
    v_lshrrev_b32 v61, 2, v23
    v_and_or_b32 v31, v61, 28, v31
    v_add_u32 v60, 65440, v60
    v_lshl_or_b32 v32, v32, 17, v60
    v_lshrrev_b32 v61, 2, v24
    v_and_or_b32 v32, v61, 28, v32
    v_add_u32 v60, 32, v60
    v_lshl_or_b32 v33, v33, 17, v60
    v_lshrrev_b32 v61, 2, v25
    v_and_or_b32 v33, v61, 28, v33
    v_add_u32 v60, 32, v60
    v_lshl_or_b32 v34, v34, 17, v60
    v_lshrrev_b32 v61, 2, v26
    v_and_or_b32 v34, v61, 28, v34
    v_add_u32 v60, 32, v60
    v_lshl_or_b32 v35, v35, 17, v60
    v_lshrrev_b32 v61, 2, v27
    v_and_or_b32 v35, v61, 28, v35
    s_waitcnt lgkmcnt(0)
    s_barrier
    ds_read_b128 v[232:235], v16 offset:20480
    s_waitcnt lgkmcnt(0)
    v_add_u32 v236, 3, v232
    v_lshrrev_b32 v236, 2, v236
    v_add_u32 v237, 3, v233
    v_lshrrev_b32 v237, 2, v237
    v_add_u32 v238, 3, v234
    v_lshrrev_b32 v238, 2, v238
    v_add_u32 v239, 3, v235
    v_lshrrev_b32 v239, 2, v239
    v_add_u32 v237, v236, v237
    v_add_u32 v238, v237, v238
    v_add_u32 v239, v238, v239
    v_mov_b32 v62, v239
    s_nop 1
    v_add_u32_dpp v62, v62, v62 row_shr:1 row_mask:0xf bank_mask:0xf bound_ctrl:0
    s_nop 1
    v_add_u32_dpp v62, v62, v62 row_shr:2 row_mask:0xf bank_mask:0xf bound_ctrl:0
    s_nop 1
    v_add_u32_dpp v62, v62, v62 row_shr:4 row_mask:0xf bank_mask:0xf bound_ctrl:0
    s_nop 1
    v_add_u32_dpp v62, v62, v62 row_shr:8 row_mask:0xf bank_mask:0xf bound_ctrl:0
    s_nop 1
    v_add_u32_dpp v62, v62, v62 row_bcast:15 row_mask:0xa bank_mask:0xf
    s_nop 1
    v_add_u32_dpp v62, v62, v62 row_bcast:31 row_mask:0xc bank_mask:0xf
    v_sub_u32 v240, v62, v239
    v_readlane_b32 s86, v62, 63
    v_add_u32 v241, v240, v236
    v_add_u32 v242, v240, v237
    v_add_u32 v243, v240, v238
    ds_write_b128 v16, v[240:243] offset:21504
    ds_read_b32 v36, v36 offset:21504
    ds_read_b32 v37, v37 offset:21504
    ds_read_b32 v38, v38 offset:21504
    ds_read_b32 v39, v39 offset:21504
    ds_read_b32 v40, v40 offset:21504
    ds_read_b32 v41, v41 offset:21504
    ds_read_b32 v42, v42 offset:21504
    ds_read_b32 v43, v43 offset:21504
    s_waitcnt lgkmcnt(7)
    v_lshl_add_u32 v44, v36, 2, v44
    v_and_b32 v36, -4, v44
    v_lshl_add_u32 v61, v44, 2, v36
    v_lshl_add_u32 v62, v36, 2, v44
    ds_write_b32 v61, v28
    ds_write_b8 v62, v20 offset:16
    s_waitcnt lgkmcnt(8)
    v_lshl_add_u32 v45, v37, 2, v45
    v_and_b32 v37, -4, v45
    v_lshl_add_u32 v61, v45, 2, v37
    v_lshl_add_u32 v62, v37, 2, v45
    ds_write_b32 v61, v29
    ds_write_b8 v62, v21 offset:16
    s_waitcnt lgkmcnt(9)
    v_lshl_add_u32 v46, v38, 2, v46
    v_and_b32 v38, -4, v46
    v_lshl_add_u32 v61, v46, 2, v38
    v_lshl_add_u32 v62, v38, 2, v46
    ds_write_b32 v61, v30
    ds_write_b8 v62, v22 offset:16
    s_waitcnt lgkmcnt(10)
    v_lshl_add_u32 v47, v39, 2, v47
    v_and_b32 v39, -4, v47
    v_lshl_add_u32 v61, v47, 2, v39
    v_lshl_add_u32 v62, v39, 2, v47
    ds_write_b32 v61, v31
    ds_write_b8 v62, v23 offset:16
    s_waitcnt lgkmcnt(11)
    v_lshl_add_u32 v48, v40, 2, v48
    v_and_b32 v40, -4, v48
    v_lshl_add_u32 v61, v48, 2, v40
    v_lshl_add_u32 v62, v40, 2, v48
    s_mov_b64 exec, s[4:5]
    ds_write_b32 v61, v32
    ds_write_b8 v62, v24 offset:16
    s_waitcnt lgkmcnt(12)
    v_lshl_add_u32 v49, v41, 2, v49
    v_and_b32 v41, -4, v49
    v_lshl_add_u32 v61, v49, 2, v41
    v_lshl_add_u32 v62, v41, 2, v49
    s_mov_b64 exec, s[6:7]
    ds_write_b32 v61, v33
    ds_write_b8 v62, v25 offset:16
    s_waitcnt lgkmcnt(13)
    v_lshl_add_u32 v50, v42, 2, v50
    v_and_b32 v42, -4, v50
    v_lshl_add_u32 v61, v50, 2, v42
    v_lshl_add_u32 v62, v42, 2, v50
    ds_write_b32 v61, v34
    ds_write_b8 v62, v26 offset:16
    s_waitcnt lgkmcnt(14)
    v_lshl_add_u32 v51, v43, 2, v51
    v_and_b32 v43, -4, v51
    v_lshl_add_u32 v61, v51, 2, v43
    v_lshl_add_u32 v62, v43, 2, v51
    ds_write_b32 v61, v35
    ds_write_b8 v62, v27 offset:16
    s_mov_b64 exec, -1
    buffer_load_dwordx2 v[58:59], v0, s[56:59], 0 offen sc1
    s_waitcnt lgkmcnt(0)
    s_barrier
    ds_read_b128 v[20:23], v17 offset:0
    ds_read_b128 v[24:27], v17 offset:8192
    ds_read_b128 v[28:31], v17 offset:16384
    s_mul_i32 s68, s86, 20
    s_mul_i32 s69, s2, 19584
    s_add_u32 s69, s69, 1048576
    v_mov_b32 v35, 2147483616
    v_add_u32 v32, 0, v17
    v_cmp_gt_u32 vcc, s68, v32
    s_waitcnt lgkmcnt(2)
    s_nop 0
    v_cndmask_b32 v32, v35, v32, vcc
    buffer_store_dwordx4 v[20:23], v32, s[28:31], s69 offen sc0 sc1
    v_add_u32 v33, 8192, v17
    v_cmp_gt_u32 vcc, s68, v33
    s_waitcnt lgkmcnt(1)
    s_nop 0
    v_cndmask_b32 v33, v35, v33, vcc
    buffer_store_dwordx4 v[24:27], v33, s[28:31], s69 offen sc0 sc1
    v_add_u32 v34, 16384, v17
    v_cmp_gt_u32 vcc, s68, v34
    s_waitcnt lgkmcnt(0)
    s_nop 0
    v_cndmask_b32 v34, v35, v34, vcc
    buffer_store_dwordx4 v[28:31], v34, s[28:31], s69 offen sc0 sc1
    s_lshr_b32 s68, s2, 3
    s_mul_i32 s68, s68, 27
    s_lshr_b32 s68, s68, 4
    s_add_u32 s68, s68, 22
    s_add_u32 s68, s68, s3
    s_lshl_b32 s74, s68, 10
    s_sub_u32 s74, s74, 8192
    s_add_u32 s74, s74, 8192
    s_sub_u32 s68, s74, 150528
    s_cselect_b32 s74, s74, s68
    s_mov_b32 m0, s74
    s_nop 0
    buffer_load_dwordx4 v16, s[20:23], s74 offen lds
    s_add_u32 s74, s74, 8192
    s_sub_u32 s68, s74, 150528
    s_cselect_b32 s74, s74, s68
    s_mov_b32 m0, s74
    s_nop 0
    buffer_load_dwordx4 v16, s[20:23], s74 offen lds
    s_add_u32 s74, s74, 8192
    s_sub_u32 s68, s74, 150528
    s_cselect_b32 s74, s74, s68
    s_mov_b32 m0, s74
    s_nop 0
    buffer_load_dwordx4 v16, s[20:23], s74 offen lds
    s_add_u32 s74, s74, 8192
    s_sub_u32 s68, s74, 150528
    s_cselect_b32 s74, s74, s68
    s_mov_b32 m0, s74
    s_nop 0
    buffer_load_dwordx4 v16, s[20:23], s74 offen lds
    s_add_u32 s74, s74, 8192
    s_sub_u32 s68, s74, 150528
    s_cselect_b32 s74, s74, s68
    s_mov_b32 m0, s74
    s_nop 0
    buffer_load_dwordx4 v16, s[20:23], s74 offen lds
    s_add_u32 s74, s74, 8192
    s_sub_u32 s68, s74, 150528
    s_cselect_b32 s74, s74, s68
    s_mov_b32 m0, s74
    s_nop 0
    buffer_load_dwordx4 v16, s[20:23], s74 offen lds
    s_add_u32 s74, s74, 8192
    s_sub_u32 s68, s74, 150528
    s_cselect_b32 s74, s74, s68
    s_mov_b32 m0, s74
    s_nop 0
    buffer_load_dwordx4 v16, s[20:23], s74 offen lds
    s_add_u32 s74, s74, 8192
    s_sub_u32 s68, s74, 150528
    s_cselect_b32 s74, s74, s68
    s_mov_b32 m0, s74
    s_nop 0
    buffer_load_dwordx4 v16, s[20:23], s74 offen lds
    s_add_u32 s74, s74, 8192
    s_sub_u32 s68, s74, 150528
    s_cselect_b32 s74, s74, s68
    s_mov_b32 m0, s74
    s_nop 0
    buffer_load_dwordx4 v16, s[20:23], s74 offen lds
    s_lshl_b32 s68, s3, 10
    s_add_u32 s68, s68, 150528
    v_add_u32 v61, s68, v16
    s_waitcnt vmcnt(13)
    ds_read_b128 v[64:67], v61
    ds_read_b128 v[68:71], v61 offset:8192
    v_lshl_or_b32 v54, v55, 16, v54
    v_mov_b32 v55, v56
    v_lshl_add_u32 v53, v13, 3, s77
    s_cmp_ge_u32 s3, 2
    s_cbranch_scc1 L_nopd
    ds_write_b64 v53, v[54:55]
L_nopd:
    s_waitcnt lgkmcnt(0)
    v_lshlrev_b32 v63, 16, v64
    v_and_b32 v64, 0xffff0000, v64
    v_mul_f32 v63, s75, v63
    v_mul_f32 v64, s75, v64
    v_cvt_pk_bf16_f32 v64, v63, v64
    v_lshlrev_b32 v63, 16, v65
    v_and_b32 v65, 0xffff0000, v65
    v_mul_f32 v63, s75, v63
    v_mul_f32 v65, s75, v65
    v_cvt_pk_bf16_f32 v65, v63, v65
    v_lshlrev_b32 v63, 16, v66
    v_and_b32 v66, 0xffff0000, v66
    v_mul_f32 v63, s75, v63
    v_mul_f32 v66, s75, v66
    v_cvt_pk_bf16_f32 v66, v63, v66
    v_lshlrev_b32 v63, 16, v67
    v_and_b32 v67, 0xffff0000, v67
    v_mul_f32 v63, s75, v63
    v_mul_f32 v67, s75, v67
    v_cvt_pk_bf16_f32 v67, v63, v67
    ds_write_b128 v61, v[64:67]
    s_cmp_ge_u32 s3, 3
    s_cbranch_scc1 L_noscale2
    v_lshlrev_b32 v63, 16, v68
    v_and_b32 v68, 0xffff0000, v68
    v_mul_f32 v63, s75, v63
    v_mul_f32 v68, s75, v68
    v_cvt_pk_bf16_f32 v68, v63, v68
    v_lshlrev_b32 v63, 16, v69
    v_and_b32 v69, 0xffff0000, v69
    v_mul_f32 v63, s75, v63
    v_mul_f32 v69, s75, v69
    v_cvt_pk_bf16_f32 v69, v63, v69
    v_lshlrev_b32 v63, 16, v70
    v_and_b32 v70, 0xffff0000, v70
    v_mul_f32 v63, s75, v63
    v_mul_f32 v70, s75, v70
    v_cvt_pk_bf16_f32 v70, v63, v70
    v_lshlrev_b32 v63, 16, v71
    v_and_b32 v71, 0xffff0000, v71
    v_mul_f32 v63, s75, v63
    v_mul_f32 v71, s75, v71
    v_cvt_pk_bf16_f32 v71, v63, v71
    s_cmp_eq_u32 s3, 0
    s_cselect_b32 exec_lo, 0xffffff00, -1
    ds_write_b128 v61, v[68:71] offset:8192
    s_mov_b64 exec, -1
L_noscale2:
    s_waitcnt vmcnt(9) lgkmcnt(0)
L_tagpoll:
    v_readfirstlane_b32 s85, v59
    v_readfirstlane_b32 s84, v58
    s_cmp_lt_i32 s85, 0
    s_cbranch_scc1 L_tagok
    s_add_u32 s87, s87, 1
    s_cmp_gt_u32 s87, 400000
    s_cbranch_scc1 L_end
    buffer_load_dwordx2 v[58:59], v0, s[56:59], 0 offen sc1
    s_waitcnt vmcnt(0)
    s_branch L_tagpoll
L_tagok:
    s_lshl_b32 s85, s85, 22
    s_barrier
    s_cmp_lg_u32 s3, 0
    s_cbranch_scc1 L_nopub
    v_lshl_or_b32 v20, v232, 10, v240
    v_or_b32 v20, s85, v20
    v_mov_b32 v21, s84
    v_lshl_or_b32 v22, v233, 10, v241
    v_or_b32 v22, s85, v22
    v_mov_b32 v23, s84
    v_lshl_or_b32 v24, v234, 10, v242
    v_or_b32 v24, s85, v24
    v_mov_b32 v25, s84
    v_lshl_or_b32 v26, v235, 10, v243
    v_or_b32 v26, s85, v26
    v_mov_b32 v27, s84
    s_lshl_b32 s68, s2, 11
    s_add_u32 s68, s68, 4096
    v_lshlrev_b32 v28, 1, v16
    buffer_store_dwordx4 v[20:23], v28, s[28:31], s68 offen sc0 sc1
    buffer_store_dwordx4 v[24:27], v28, s[28:31], s68 offen offset:16 sc0 sc1
L_nopub:
    s_branch L_batch0
L_batch:
    s_barrier
    s_cmp_lg_u32 s3, 2
    s_cbranch_scc1 L_noinit1
    v_lshrrev_b32 v60, 2, v12
    v_and_b32 v61, 3, v12
    v_lshrrev_b32 v62, 1, v60
    v_cmp_eq_u32 vcc, v61, v62
    v_and_b32 v62, 1, v60
    v_lshlrev_b32 v62, 4, v62
    v_mov_b32 v63, 0x3f80
    v_lshlrev_b32 v62, v62, v63
    v_cndmask_b32 v62, 0, v62, vcc
    v_cmp_gt_u32 vcc, 7, v60
    v_lshlrev_b32 v61, 2, v12
    v_add_u32 v61, 161792, v61
    v_cndmask_b32 v62, 0, v62, vcc
    v_min_u32 v63, 2, v12
    v_lshlrev_b32 v63, 7, v63
    v_lshl_add_u32 v63, v12, 10, v63
    v_cmp_gt_u32 vcc, 16, v12
    v_add_u32 v63, 65536, v63
    s_nop 0
    v_cndmask_b32 v63, 0, v63, vcc
    s_mov_b64 exec, 0xffffffff
    ds_write_b32 v61, v63
    ds_write_b32 v61, v62 offset:128
    s_mov_b64 exec, -1
L_noinit1:
    v_lshlrev_b32 v16, 4, v12
    s_lshr_b32 s68, s2, 3
    s_mul_i32 s68, s68, 27
    s_lshr_b32 s68, s68, 4
    s_add_u32 s68, s68, 22
    s_add_u32 s68, s68, s3
    s_lshl_b32 s74, s68, 10
    s_sub_u32 s74, s74, 8192
    s_add_u32 s74, s74, 8192
    s_sub_u32 s68, s74, 150528
    s_cselect_b32 s74, s74, s68
    s_mov_b32 m0, s74
    s_nop 0
    buffer_load_dwordx4 v16, s[20:23], s74 offen lds
    s_add_u32 s74, s74, 8192
    s_sub_u32 s68, s74, 150528
    s_cselect_b32 s74, s74, s68
    s_mov_b32 m0, s74
    s_nop 0
    buffer_load_dwordx4 v16, s[20:23], s74 offen lds
    s_add_u32 s74, s74, 8192
    s_sub_u32 s68, s74, 150528
    s_cselect_b32 s74, s74, s68
    s_mov_b32 m0, s74
    s_nop 0
    buffer_load_dwordx4 v16, s[20:23], s74 offen lds
    s_add_u32 s74, s74, 8192
    s_sub_u32 s68, s74, 150528
    s_cselect_b32 s74, s74, s68
    s_mov_b32 m0, s74
    s_nop 0
    buffer_load_dwordx4 v16, s[20:23], s74 offen lds
    s_add_u32 s74, s74, 8192
    s_sub_u32 s68, s74, 150528
    s_cselect_b32 s74, s74, s68
    s_mov_b32 m0, s74
    s_nop 0
    buffer_load_dwordx4 v16, s[20:23], s74 offen lds
    s_add_u32 s74, s74, 8192
    s_sub_u32 s68, s74, 150528
    s_cselect_b32 s74, s74, s68
    s_mov_b32 m0, s74
    s_nop 0
    buffer_load_dwordx4 v16, s[20:23], s74 offen lds
    s_add_u32 s74, s74, 8192
    s_sub_u32 s68, s74, 150528
    s_cselect_b32 s74, s74, s68
    s_mov_b32 m0, s74
    s_nop 0
    buffer_load_dwordx4 v16, s[20:23], s74 offen lds
    s_add_u32 s74, s74, 8192
    s_sub_u32 s68, s74, 150528
    s_cselect_b32 s74, s74, s68
    s_mov_b32 m0, s74
    s_nop 0
    buffer_load_dwordx4 v16, s[20:23], s74 offen lds
    s_add_u32 s74, s74, 8192
    s_sub_u32 s68, s74, 150528
    s_cselect_b32 s74, s74, s68
    s_mov_b32 m0, s74
    s_nop 0
    buffer_load_dwordx4 v16, s[20:23], s74 offen lds
    s_waitcnt lgkmcnt(0)
    s_barrier
L_batch0:
    s_add_u32 s74, s74, 8192
    s_sub_u32 s68, s74, 150528
    s_cselect_b32 s74, s74, s68
    s_mov_b32 m0, s74
    s_nop 0
    buffer_load_dwordx4 v16, s[20:23], s74 offen lds
    s_add_u32 s74, s74, 8192
    s_sub_u32 s68, s74, 150528
    s_cselect_b32 s74, s74, s68
    s_mov_b32 m0, s74
    s_nop 0
    buffer_load_dwordx4 v16, s[20:23], s74 offen lds
    s_add_u32 s74, s74, 8192
    s_sub_u32 s68, s74, 150528
    s_cselect_b32 s74, s74, s68
    s_mov_b32 m0, s74
    s_nop 0
    buffer_load_dwordx4 v16, s[20:23], s74 offen lds
    s_add_u32 s74, s74, 8192
    s_sub_u32 s68, s74, 150528
    s_cselect_b32 s74, s74, s68
    s_mov_b32 m0, s74
    s_nop 0
    buffer_load_dwordx4 v16, s[20:23], s74 offen lds
    s_add_u32 s74, s74, 8192
    s_sub_u32 s68, s74, 150528
    s_cselect_b32 s74, s74, s68
    s_mov_b32 m0, s74
    s_nop 0
    buffer_load_dwordx4 v16, s[20:23], s74 offen lds
    s_add_u32 s74, s74, 8192
    s_sub_u32 s68, s74, 150528
    s_cselect_b32 s74, s74, s68
    s_mov_b32 m0, s74
    s_nop 0
    buffer_load_dwordx4 v16, s[20:23], s74 offen lds
    s_add_u32 s74, s74, 8192
    s_sub_u32 s68, s74, 150528
    s_cselect_b32 s74, s74, s68
    s_mov_b32 m0, s74
    s_nop 0
    buffer_load_dwordx4 v16, s[20:23], s74 offen lds
    s_add_u32 s74, s74, 8192
    s_sub_u32 s68, s74, 150528
    s_cselect_b32 s74, s74, s68
    s_mov_b32 m0, s74
    s_nop 0
    buffer_load_dwordx4 v16, s[20:23], s74 offen lds
    s_add_u32 s74, s74, 8192
    s_sub_u32 s68, s74, 150528
    s_cselect_b32 s74, s74, s68
    s_mov_b32 m0, s74
    s_nop 0
    buffer_load_dwordx4 v16, s[20:23], s74 offen lds
    s_mov_b32 s78, s3
    s_sub_u32 s79, 15, s3
    v_add_u32 v20, 150528, v76
    ds_read_b64_tr_b16 v[80:81], v20 offset:0
    ds_read_b64_tr_b16 v[82:83], v20 offset:512
    ds_read_b64_tr_b16 v[84:85], v20 offset:64
    ds_read_b64_tr_b16 v[86:87], v20 offset:576
    ds_read_b64_tr_b16 v[88:89], v20 offset:2048
    ds_read_b64_tr_b16 v[90:91], v20 offset:2560
    ds_read_b64_tr_b16 v[92:93], v20 offset:2112
    ds_read_b64_tr_b16 v[94:95], v20 offset:2624
    ds_read_b64_tr_b16 v[96:97], v20 offset:4096
    ds_read_b64_tr_b16 v[98:99], v20 offset:4608
    ds_read_b64_tr_b16 v[100:101], v20 offset:4160
    ds_read_b64_tr_b16 v[102:103], v20 offset:4672
    ds_read_b64_tr_b16 v[104:105], v20 offset:6144
    ds_read_b64_tr_b16 v[106:107], v20 offset:6656
    ds_read_b64_tr_b16 v[108:109], v20 offset:6208
    ds_read_b64_tr_b16 v[110:111], v20 offset:6720
    ds_read_b64_tr_b16 v[112:113], v20 offset:8320
    ds_read_b64_tr_b16 v[114:115], v20 offset:8832
    ds_read_b64_tr_b16 v[116:117], v20 offset:8384
    ds_read_b64_tr_b16 v[118:119], v20 offset:8896
    v_lshrrev_b32 v21, 1, v13
    v_lshlrev_b32 v22, 11, v21
    s_lshl_b32 s69, s60, 3
    s_add_u32 s69, s69, 4096
L_poll:
    buffer_load_dwordx2 v[24:25], v22, s[28:31], s69 offen sc1
    s_waitcnt vmcnt(0)
    v_and_b32 v23, 0xffc00000, v24
    v_cmp_ne_u32 vcc, s84, v25
    v_cmp_ne_u32 s[4:5], s85, v23
    s_add_u32 s87, s87, 1
    s_or_b64 vcc, vcc, s[4:5]
    s_cbranch_scc0 L_polled
    s_cmp_gt_u32 s87, 400000
    s_cbranch_scc0 L_poll
    s_endpgm
L_polled:
    v_subrev_u32 v22, s63, v21
    v_cmp_gt_u32 vcc, s64, v22
    v_bfe_u32 v14, v24, 10, 12
    v_and_b32 v20, 0x3ff, v24
    v_cndmask_b32 v14, 0, v14, vcc
    v_subrev_u32 v14, s65, v14
    v_and_b32 v22, 1, v13
    s_lshr_b32 s68, s65, 2
    v_add3_u32 v20, v20, v22, s68
    v_mul_u32_u24 v20, 20, v20
    s_mov_b32 s68, 19584
    v_mad_u32_u24 v20, v21, s68, v20
    v_cmp_lt_i32 s[4:5], 32, v14
    v_lshlrev_b32 v22, 2, v22
    v_sub_u32 v14, v14, v22
    v_mov_b32 v23, 2147483616
    s_mov_b32 s68, 1048576
    v_cmp_lt_i32 vcc, 0, v14
    s_nop 1
    v_cndmask_b32 v24, v23, v20, vcc
    buffer_load_dwordx4 v[52:55], v24, s[28:31], s68 offen offset:0
    buffer_load_dword v248, v24, s[28:31], s68 offen offset:16
    v_cmp_lt_i32 vcc, 8, v14
    s_nop 1
    v_cndmask_b32 v25, v23, v20, vcc
    buffer_load_dwordx4 v[56:59], v25, s[28:31], s68 offen offset:40
    buffer_load_dword v249, v25, s[28:31], s68 offen offset:56
    v_cmp_lt_i32 vcc, 16, v14
    s_nop 1
    v_cndmask_b32 v26, v23, v20, vcc
    buffer_load_dwordx4 v[60:63], v26, s[28:31], s68 offen offset:80
    buffer_load_dword v250, v26, s[28:31], s68 offen offset:96
    v_cmp_lt_i32 vcc, 24, v14
    s_nop 1
    v_cndmask_b32 v27, v23, v20, vcc
    buffer_load_dwordx4 v[64:67], v27, s[28:31], s68 offen offset:120
    buffer_load_dword v251, v27, s[28:31], s68 offen offset:136
    s_mov_b32 s68, 100000
    v_mul_u32_u24 v15, s68, v21
    v_mov_b32 v17, 4
    s_cmp_eq_u64 s[4:5], 0
    s_cbranch_scc1 L_noflag
    v_mov_b32 v28, 161856
    ds_write_b32 v28, v17
L_noflag:
    s_cmp_ge_u32 s3, 3
    s_cbranch_scc1 L_posdone
    s_add_u32 s74, s74, 8192
    s_sub_u32 s68, s74, 150528
    s_cselect_b32 s74, s74, s68
    s_mov_b32 m0, s74
    s_nop 0
    buffer_load_dwordx4 v16, s[20:23], s74 offen lds
L_posdone:
    s_waitcnt vmcnt(0)
    s_mov_b32 s68, 161792
    v_bfe_u32 v152, v248, 0, 8
    v_cmp_lt_i32 vcc, 0, v14
    v_lshrrev_b32 v232, 17, v52
    v_and_b32 v136, 0x1ffff, v52
    v_and_b32 v52, 15, v152
    v_lshl_add_u32 v52, v52, 2, s68
    s_mov_b64 exec, vcc
    ds_add_rtn_u32 v52, v52, v17
    s_mov_b64 exec, -1
    v_add_u32 v136, v136, v15
    v_mul_u32_u24 v20, 6, v232
    v_lshl_add_u32 v22, v152, 3, s77
    v_lshlrev_b32 v68, 3, v20
    v_and_b32 v20, -4, v20
    v_bfe_u32 v153, v248, 8, 8
    v_cmp_lt_i32 vcc, 1, v14
    v_lshrrev_b32 v233, 17, v53
    v_and_b32 v137, 0x1ffff, v53
    v_and_b32 v53, 15, v153
    v_lshl_add_u32 v53, v53, 2, s68
    s_mov_b64 exec, vcc
    ds_add_rtn_u32 v53, v53, v17
    s_mov_b64 exec, -1
    v_add_u32 v137, v137, v15
    v_mul_u32_u24 v24, 6, v233
    v_lshl_add_u32 v26, v153, 3, s77
    v_lshlrev_b32 v69, 3, v24
    v_and_b32 v24, -4, v24
    v_bfe_u32 v154, v248, 16, 8
    v_cmp_lt_i32 vcc, 2, v14
    v_lshrrev_b32 v234, 17, v54
    v_and_b32 v138, 0x1ffff, v54
    v_and_b32 v54, 15, v154
    v_lshl_add_u32 v54, v54, 2, s68
    s_mov_b64 exec, vcc
    ds_add_rtn_u32 v54, v54, v17
    s_mov_b64 exec, -1
    v_add_u32 v138, v138, v15
    v_mul_u32_u24 v28, 6, v234
    v_lshl_add_u32 v30, v154, 3, s77
    v_lshlrev_b32 v70, 3, v28
    v_and_b32 v28, -4, v28
    v_bfe_u32 v155, v248, 24, 8
    v_cmp_lt_i32 vcc, 3, v14
    v_lshrrev_b32 v235, 17, v55
    v_and_b32 v139, 0x1ffff, v55
    v_and_b32 v55, 15, v155
    v_lshl_add_u32 v55, v55, 2, s68
    s_mov_b64 exec, vcc
    ds_add_rtn_u32 v55, v55, v17
    s_mov_b64 exec, -1
    v_add_u32 v139, v139, v15
    v_mul_u32_u24 v32, 6, v235
    v_lshl_add_u32 v34, v155, 3, s77
    v_lshlrev_b32 v71, 3, v32
    v_and_b32 v32, -4, v32
    v_bfe_u32 v156, v249, 0, 8
    v_cmp_lt_i32 vcc, 8, v14
    v_lshrrev_b32 v236, 17, v56
    v_and_b32 v140, 0x1ffff, v56
    v_and_b32 v56, 15, v156
    v_lshl_add_u32 v56, v56, 2, s68
    s_mov_b64 exec, vcc
    ds_add_rtn_u32 v56, v56, v17
    s_mov_b64 exec, -1
    v_add_u32 v140, v140, v15
    v_mul_u32_u24 v36, 6, v236
    v_lshl_add_u32 v38, v156, 3, s77
    v_lshlrev_b32 v72, 3, v36
    v_and_b32 v36, -4, v36
    v_bfe_u32 v157, v249, 8, 8
    v_cmp_lt_i32 vcc, 9, v14
    v_lshrrev_b32 v237, 17, v57
    v_and_b32 v141, 0x1ffff, v57
    v_and_b32 v57, 15, v157
    v_lshl_add_u32 v57, v57, 2, s68
    s_mov_b64 exec, vcc
    ds_add_rtn_u32 v57, v57, v17
    s_mov_b64 exec, -1
    v_add_u32 v141, v141, v15
    v_mul_u32_u24 v40, 6, v237
    v_lshl_add_u32 v42, v157, 3, s77
    v_lshlrev_b32 v73, 3, v40
    v_and_b32 v40, -4, v40
    v_bfe_u32 v158, v249, 16, 8
    v_cmp_lt_i32 vcc, 10, v14
    v_lshrrev_b32 v238, 17, v58
    v_and_b32 v142, 0x1ffff, v58
    v_and_b32 v58, 15, v158
    v_lshl_add_u32 v58, v58, 2, s68
    s_mov_b64 exec, vcc
    ds_add_rtn_u32 v58, v58, v17
    s_mov_b64 exec, -1
    v_add_u32 v142, v142, v15
    v_mul_u32_u24 v44, 6, v238
    v_lshl_add_u32 v46, v158, 3, s77
    v_lshlrev_b32 v74, 3, v44
    v_and_b32 v44, -4, v44
    v_bfe_u32 v159, v249, 24, 8
    v_cmp_lt_i32 vcc, 11, v14
    v_lshrrev_b32 v239, 17, v59
    v_and_b32 v143, 0x1ffff, v59
    v_and_b32 v59, 15, v159
    v_lshl_add_u32 v59, v59, 2, s68
    s_mov_b64 exec, vcc
    ds_add_rtn_u32 v59, v59, v17
    s_mov_b64 exec, -1
    v_add_u32 v143, v143, v15
    v_mul_u32_u24 v48, 6, v239
    v_lshl_add_u32 v50, v159, 3, s77
    v_lshlrev_b32 v75, 3, v48
    v_and_b32 v48, -4, v48
    v_bfe_u32 v160, v250, 0, 8
    v_cmp_lt_i32 vcc, 16, v14
    v_lshrrev_b32 v240, 17, v60
    v_and_b32 v144, 0x1ffff, v60
    v_and_b32 v60, 15, v160
    v_lshl_add_u32 v60, v60, 2, s68
    s_mov_b64 exec, vcc
    ds_add_rtn_u32 v60, v60, v17
    s_mov_b64 exec, -1
    v_add_u32 v144, v144, v15
    v_bfe_u32 v161, v250, 8, 8
    v_cmp_lt_i32 vcc, 17, v14
    v_lshrrev_b32 v241, 17, v61
    v_and_b32 v145, 0x1ffff, v61
    v_and_b32 v61, 15, v161
    v_lshl_add_u32 v61, v61, 2, s68
    s_mov_b64 exec, vcc
    ds_add_rtn_u32 v61, v61, v17
    s_mov_b64 exec, -1
    v_add_u32 v145, v145, v15
    v_bfe_u32 v162, v250, 16, 8
    v_cmp_lt_i32 vcc, 18, v14
    v_lshrrev_b32 v242, 17, v62
    v_and_b32 v146, 0x1ffff, v62
    v_and_b32 v62, 15, v162
    v_lshl_add_u32 v62, v62, 2, s68
    s_mov_b64 exec, vcc
    ds_add_rtn_u32 v62, v62, v17
    s_mov_b64 exec, -1
    v_add_u32 v146, v146, v15
    v_bfe_u32 v163, v250, 24, 8
    v_cmp_lt_i32 vcc, 19, v14
    v_lshrrev_b32 v243, 17, v63
    v_and_b32 v147, 0x1ffff, v63
    v_and_b32 v63, 15, v163
    v_lshl_add_u32 v63, v63, 2, s68
    s_mov_b64 exec, vcc
    ds_add_rtn_u32 v63, v63, v17
    s_mov_b64 exec, -1
    v_add_u32 v147, v147, v15
    s_waitcnt vmcnt(0)
    s_barrier
    ds_read2_b32 v[20:21], v20 offset0:0 offset1:1
    ds_read_b64 v[22:23], v22
    ds_read2_b32 v[24:25], v24 offset0:0 offset1:1
    ds_read_b64 v[26:27], v26
    ds_read2_b32 v[28:29], v28 offset0:0 offset1:1
    ds_read_b64 v[30:31], v30
    ds_read2_b32 v[32:33], v32 offset0:0 offset1:1
    ds_read_b64 v[34:35], v34
    v_cmp_lt_i32 vcc, 8, v14
    s_nop 0
    s_mov_b64 exec, vcc
    ds_read2_b32 v[36:37], v36 offset0:0 offset1:1
    ds_read_b64 v[38:39], v38
    s_mov_b64 exec, -1
    v_cmp_lt_i32 vcc, 9, v14
    s_nop 0
    s_mov_b64 exec, vcc
    ds_read2_b32 v[40:41], v40 offset0:0 offset1:1
    ds_read_b64 v[42:43], v42
    s_mov_b64 exec, -1
    v_cmp_lt_i32 vcc, 10, v14
    s_nop 0
    s_mov_b64 exec, vcc
    ds_read2_b32 v[44:45], v44 offset0:0 offset1:1
    ds_read_b64 v[46:47], v46
    s_mov_b64 exec, -1
    s_lshr_b32 s74, s2, 3
    s_mul_i32 s74, s74, 100096
    v_mov_b32 v79, 2147483616
    v_lshl_add_u32 v18, v12, 3, s3
    v_cmp_gt_u32 vcc, 382, v18
    v_add_u32 v18, 160, v18
    v_lshlrev_b32 v18, 7, v18
    v_cndmask_b32 v18, v79, v18, vcc
    v_lshl_add_u32 v19, v12, 3, s3
    v_cmp_gt_u32 vcc, 0, v19
    v_add_u32 v19, 542, v19
    v_lshlrev_b32 v19, 7, v19
    v_cndmask_b32 v19, v79, v19, vcc
    s_waitcnt lgkmcnt(12)
    v_alignbit_b32 v20, v21, v20, v68
    v_lshrrev_b32 v21, v68, v21
    v_lshlrev_b32 v23, 16, v23
    v_lshlrev_b32 v21, 16, v21
    v_and_b32 v152, 0xffff0000, v22
    v_and_b32 v68, 0xffff0000, v20
    v_lshlrev_b32 v22, 16, v22
    v_lshlrev_b32 v20, 16, v20
    v_sub_f32 v23, v23, v21
    v_sub_f32 v152, v152, v68
    v_sub_f32 v22, v22, v20
    v_cvt_pk_bf16_f32 v152, v152, v23
    v_cvt_pk_bf16_f32 v22, 0, v22
    v_or_b32 v232, v232, v22
    v_cmp_lt_i32 vcc, 11, v14
    s_nop 0
    s_mov_b64 exec, vcc
    ds_read2_b32 v[48:49], v48 offset0:0 offset1:1
    ds_read_b64 v[50:51], v50
    s_mov_b64 exec, -1
    s_waitcnt lgkmcnt(12)
    v_alignbit_b32 v24, v25, v24, v69
    v_lshrrev_b32 v25, v69, v25
    v_lshlrev_b32 v27, 16, v27
    v_lshlrev_b32 v25, 16, v25
    v_and_b32 v153, 0xffff0000, v26
    v_and_b32 v69, 0xffff0000, v24
    v_lshlrev_b32 v26, 16, v26
    v_lshlrev_b32 v24, 16, v24
    v_sub_f32 v27, v27, v25
    v_sub_f32 v153, v153, v69
    v_sub_f32 v26, v26, v24
    v_cvt_pk_bf16_f32 v153, v153, v27
    v_cvt_pk_bf16_f32 v26, 0, v26
    v_or_b32 v233, v233, v26
    v_mul_u32_u24 v20, 6, v240
    v_lshl_add_u32 v22, v160, 3, s77
    v_lshlrev_b32 v68, 3, v20
    v_and_b32 v20, -4, v20
    v_cmp_lt_i32 vcc, 16, v14
    s_nop 0
    s_mov_b64 exec, vcc
    ds_read2_b32 v[20:21], v20 offset0:0 offset1:1
    ds_read_b64 v[22:23], v22
    s_mov_b64 exec, -1
    s_waitcnt lgkmcnt(12)
    v_alignbit_b32 v28, v29, v28, v70
    v_lshrrev_b32 v29, v70, v29
    v_lshlrev_b32 v31, 16, v31
    v_lshlrev_b32 v29, 16, v29
    v_and_b32 v154, 0xffff0000, v30
    v_and_b32 v70, 0xffff0000, v28
    v_lshlrev_b32 v30, 16, v30
    v_lshlrev_b32 v28, 16, v28
    v_sub_f32 v31, v31, v29
    v_sub_f32 v154, v154, v70
    v_sub_f32 v30, v30, v28
    v_cvt_pk_bf16_f32 v154, v154, v31
    v_cvt_pk_bf16_f32 v30, 0, v30
    v_or_b32 v234, v234, v30
    v_mul_u32_u24 v24, 6, v241
    v_lshl_add_u32 v26, v161, 3, s77
    v_lshlrev_b32 v69, 3, v24
    v_and_b32 v24, -4, v24
    v_cmp_lt_i32 vcc, 17, v14
    s_nop 0
    s_mov_b64 exec, vcc
    ds_read2_b32 v[24:25], v24 offset0:0 offset1:1
    ds_read_b64 v[26:27], v26
    s_mov_b64 exec, -1
    s_waitcnt lgkmcnt(12)
    v_alignbit_b32 v32, v33, v32, v71
    v_lshrrev_b32 v33, v71, v33
    v_lshlrev_b32 v35, 16, v35
    v_lshlrev_b32 v33, 16, v33
    v_and_b32 v155, 0xffff0000, v34
    v_and_b32 v71, 0xffff0000, v32
    v_lshlrev_b32 v34, 16, v34
    v_lshlrev_b32 v32, 16, v32
    v_sub_f32 v35, v35, v33
    v_sub_f32 v155, v155, v71
    v_sub_f32 v34, v34, v32
    v_cvt_pk_bf16_f32 v155, v155, v35
    v_cvt_pk_bf16_f32 v34, 0, v34
    v_or_b32 v235, v235, v34
    v_mul_u32_u24 v28, 6, v242
    v_lshl_add_u32 v30, v162, 3, s77
    v_lshlrev_b32 v70, 3, v28
    v_and_b32 v28, -4, v28
    v_cmp_lt_i32 vcc, 18, v14
    s_nop 0
    s_mov_b64 exec, vcc
    ds_read2_b32 v[28:29], v28 offset0:0 offset1:1
    ds_read_b64 v[30:31], v30
    s_mov_b64 exec, -1
    s_waitcnt lgkmcnt(12)
    v_alignbit_b32 v36, v37, v36, v72
    v_lshrrev_b32 v37, v72, v37
    v_lshlrev_b32 v39, 16, v39
    v_lshlrev_b32 v37, 16, v37
    v_and_b32 v156, 0xffff0000, v38
    v_and_b32 v72, 0xffff0000, v36
    v_lshlrev_b32 v38, 16, v38
    v_lshlrev_b32 v36, 16, v36
    v_sub_f32 v39, v39, v37
    v_sub_f32 v156, v156, v72
    v_sub_f32 v38, v38, v36
    v_cvt_pk_bf16_f32 v156, v156, v39
    v_cvt_pk_bf16_f32 v38, 0, v38
    v_or_b32 v236, v236, v38
    v_mul_u32_u24 v32, 6, v243
    v_lshl_add_u32 v34, v163, 3, s77
    v_lshlrev_b32 v71, 3, v32
    v_and_b32 v32, -4, v32
    v_cmp_lt_i32 vcc, 19, v14
    s_nop 0
    s_mov_b64 exec, vcc
    ds_read2_b32 v[32:33], v32 offset0:0 offset1:1
    ds_read_b64 v[34:35], v34
    s_mov_b64 exec, -1
    s_waitcnt lgkmcnt(12)
    v_alignbit_b32 v40, v41, v40, v73
    v_lshrrev_b32 v41, v73, v41
    v_lshlrev_b32 v43, 16, v43
    v_lshlrev_b32 v41, 16, v41
    v_and_b32 v157, 0xffff0000, v42
    v_and_b32 v73, 0xffff0000, v40
    v_lshlrev_b32 v42, 16, v42
    v_lshlrev_b32 v40, 16, v40
    v_sub_f32 v43, v43, v41
    v_sub_f32 v157, v157, v73
    v_sub_f32 v42, v42, v40
    v_cvt_pk_bf16_f32 v157, v157, v43
    v_cvt_pk_bf16_f32 v42, 0, v42
    v_or_b32 v237, v237, v42
    s_waitcnt lgkmcnt(10)
    v_alignbit_b32 v44, v45, v44, v74
    v_lshrrev_b32 v45, v74, v45
    v_lshlrev_b32 v47, 16, v47
    v_lshlrev_b32 v45, 16, v45
    v_and_b32 v158, 0xffff0000, v46
    v_and_b32 v74, 0xffff0000, v44
    v_lshlrev_b32 v46, 16, v46
    v_lshlrev_b32 v44, 16, v44
    v_sub_f32 v47, v47, v45
    v_sub_f32 v158, v158, v74
    v_sub_f32 v46, v46, v44
    v_cvt_pk_bf16_f32 v158, v158, v47
    v_cvt_pk_bf16_f32 v46, 0, v46
    v_or_b32 v238, v238, v46
    s_waitcnt lgkmcnt(8)
    v_alignbit_b32 v48, v49, v48, v75
    v_lshrrev_b32 v49, v75, v49
    v_lshlrev_b32 v51, 16, v51
    v_lshlrev_b32 v49, 16, v49
    v_and_b32 v159, 0xffff0000, v50
    v_and_b32 v75, 0xffff0000, v48
    v_lshlrev_b32 v50, 16, v50
    v_lshlrev_b32 v48, 16, v48
    v_sub_f32 v51, v51, v49
    v_sub_f32 v159, v159, v75
    v_sub_f32 v50, v50, v48
    v_cvt_pk_bf16_f32 v159, v159, v51
    v_cvt_pk_bf16_f32 v50, 0, v50
    v_or_b32 v239, v239, v50
    s_waitcnt lgkmcnt(6)
    v_alignbit_b32 v20, v21, v20, v68
    v_lshrrev_b32 v21, v68, v21
    v_lshlrev_b32 v23, 16, v23
    v_lshlrev_b32 v21, 16, v21
    v_and_b32 v160, 0xffff0000, v22
    v_and_b32 v68, 0xffff0000, v20
    v_lshlrev_b32 v22, 16, v22
    v_lshlrev_b32 v20, 16, v20
    v_sub_f32 v23, v23, v21
    v_sub_f32 v160, v160, v68
    v_sub_f32 v22, v22, v20
    v_cvt_pk_bf16_f32 v160, v160, v23
    v_cvt_pk_bf16_f32 v22, 0, v22
    v_or_b32 v240, v240, v22
    s_waitcnt lgkmcnt(4)
    v_alignbit_b32 v24, v25, v24, v69
    v_lshrrev_b32 v25, v69, v25
    v_lshlrev_b32 v27, 16, v27
    v_lshlrev_b32 v25, 16, v25
    v_and_b32 v161, 0xffff0000, v26
    v_and_b32 v69, 0xffff0000, v24
    v_lshlrev_b32 v26, 16, v26
    v_lshlrev_b32 v24, 16, v24
    v_sub_f32 v27, v27, v25
    v_sub_f32 v161, v161, v69
    v_sub_f32 v26, v26, v24
    v_cvt_pk_bf16_f32 v161, v161, v27
    v_cvt_pk_bf16_f32 v26, 0, v26
    v_or_b32 v241, v241, v26
    s_waitcnt lgkmcnt(2)
    v_alignbit_b32 v28, v29, v28, v70
    v_lshrrev_b32 v29, v70, v29
    v_lshlrev_b32 v31, 16, v31
    v_lshlrev_b32 v29, 16, v29
    v_and_b32 v162, 0xffff0000, v30
    v_and_b32 v70, 0xffff0000, v28
    v_lshlrev_b32 v30, 16, v30
    v_lshlrev_b32 v28, 16, v28
    v_sub_f32 v31, v31, v29
    v_sub_f32 v162, v162, v70
    v_sub_f32 v30, v30, v28
    v_cvt_pk_bf16_f32 v162, v162, v31
    v_cvt_pk_bf16_f32 v30, 0, v30
    v_or_b32 v242, v242, v30
    s_waitcnt lgkmcnt(0)
    v_alignbit_b32 v32, v33, v32, v71
    v_lshrrev_b32 v33, v71, v33
    v_lshlrev_b32 v35, 16, v35
    v_lshlrev_b32 v33, 16, v33
    v_and_b32 v163, 0xffff0000, v34
    v_and_b32 v71, 0xffff0000, v32
    v_lshlrev_b32 v34, 16, v34
    v_lshlrev_b32 v32, 16, v32
    v_sub_f32 v35, v35, v33
    v_sub_f32 v163, v163, v71
    v_sub_f32 v34, v34, v32
    v_cvt_pk_bf16_f32 v163, v163, v35
    v_cvt_pk_bf16_f32 v34, 0, v34
    v_or_b32 v243, v243, v34
    v_cmp_lt_i32 vcc, 24, v14
    s_nop 0
    s_cmp_eq_u64 vcc, 0
    s_cbranch_scc1 L_g1skip
    v_bfe_u32 v164, v251, 0, 8
    v_cmp_lt_i32 vcc, 24, v14
    v_lshrrev_b32 v244, 17, v64
    v_and_b32 v148, 0x1ffff, v64
    v_and_b32 v64, 15, v164
    v_lshl_add_u32 v64, v64, 2, s68
    s_mov_b64 exec, vcc
    ds_add_rtn_u32 v64, v64, v17
    s_mov_b64 exec, -1
    v_add_u32 v148, v148, v15
    v_mul_u32_u24 v36, 6, v244
    v_lshl_add_u32 v38, v164, 3, s77
    v_lshlrev_b32 v72, 3, v36
    v_and_b32 v36, -4, v36
    v_cmp_lt_i32 vcc, 24, v14
    s_nop 0
    s_mov_b64 exec, vcc
    ds_read2_b32 v[36:37], v36 offset0:0 offset1:1
    ds_read_b64 v[38:39], v38
    s_mov_b64 exec, -1
    s_waitcnt lgkmcnt(0)
    v_alignbit_b32 v36, v37, v36, v72
    v_lshrrev_b32 v37, v72, v37
    v_lshlrev_b32 v39, 16, v39
    v_lshlrev_b32 v37, 16, v37
    v_and_b32 v164, 0xffff0000, v38
    v_and_b32 v72, 0xffff0000, v36
    v_lshlrev_b32 v38, 16, v38
    v_lshlrev_b32 v36, 16, v36
    v_sub_f32 v39, v39, v37
    v_sub_f32 v164, v164, v72
    v_sub_f32 v38, v38, v36
    v_cvt_pk_bf16_f32 v164, v164, v39
    v_cvt_pk_bf16_f32 v38, 0, v38
    v_or_b32 v244, v244, v38
    v_cmp_lt_i32 vcc, 25, v14
    s_nop 0
    s_cmp_eq_u64 vcc, 0
    s_cbranch_scc1 L_g1skip
    v_bfe_u32 v165, v251, 8, 8
    v_cmp_lt_i32 vcc, 25, v14
    v_lshrrev_b32 v245, 17, v65
    v_and_b32 v149, 0x1ffff, v65
    v_and_b32 v65, 15, v165
    v_lshl_add_u32 v65, v65, 2, s68
    s_mov_b64 exec, vcc
    ds_add_rtn_u32 v65, v65, v17
    s_mov_b64 exec, -1
    v_add_u32 v149, v149, v15
    v_mul_u32_u24 v40, 6, v245
    v_lshl_add_u32 v42, v165, 3, s77
    v_lshlrev_b32 v73, 3, v40
    v_and_b32 v40, -4, v40
    v_cmp_lt_i32 vcc, 25, v14
    s_nop 0
    s_mov_b64 exec, vcc
    ds_read2_b32 v[40:41], v40 offset0:0 offset1:1
    ds_read_b64 v[42:43], v42
    s_mov_b64 exec, -1
    s_waitcnt lgkmcnt(0)
    v_alignbit_b32 v40, v41, v40, v73
    v_lshrrev_b32 v41, v73, v41
    v_lshlrev_b32 v43, 16, v43
    v_lshlrev_b32 v41, 16, v41
    v_and_b32 v165, 0xffff0000, v42
    v_and_b32 v73, 0xffff0000, v40
    v_lshlrev_b32 v42, 16, v42
    v_lshlrev_b32 v40, 16, v40
    v_sub_f32 v43, v43, v41
    v_sub_f32 v165, v165, v73
    v_sub_f32 v42, v42, v40
    v_cvt_pk_bf16_f32 v165, v165, v43
    v_cvt_pk_bf16_f32 v42, 0, v42
    v_or_b32 v245, v245, v42
    v_cmp_lt_i32 vcc, 26, v14
    s_nop 0
    s_cmp_eq_u64 vcc, 0
    s_cbranch_scc1 L_g1skip
    v_bfe_u32 v166, v251, 16, 8
    v_cmp_lt_i32 vcc, 26, v14
    v_lshrrev_b32 v246, 17, v66
    v_and_b32 v150, 0x1ffff, v66
    v_and_b32 v66, 15, v166
    v_lshl_add_u32 v66, v66, 2, s68
    s_mov_b64 exec, vcc
    ds_add_rtn_u32 v66, v66, v17
    s_mov_b64 exec, -1
    v_add_u32 v150, v150, v15
    v_mul_u32_u24 v44, 6, v246
    v_lshl_add_u32 v46, v166, 3, s77
    v_lshlrev_b32 v74, 3, v44
    v_and_b32 v44, -4, v44
    v_cmp_lt_i32 vcc, 26, v14
    s_nop 0
    s_mov_b64 exec, vcc
    ds_read2_b32 v[44:45], v44 offset0:0 offset1:1
    ds_read_b64 v[46:47], v46
    s_mov_b64 exec, -1
    s_waitcnt lgkmcnt(0)
    v_alignbit_b32 v44, v45, v44, v74
    v_lshrrev_b32 v45, v74, v45
    v_lshlrev_b32 v47, 16, v47
    v_lshlrev_b32 v45, 16, v45
    v_and_b32 v166, 0xffff0000, v46
    v_and_b32 v74, 0xffff0000, v44
    v_lshlrev_b32 v46, 16, v46
    v_lshlrev_b32 v44, 16, v44
    v_sub_f32 v47, v47, v45
    v_sub_f32 v166, v166, v74
    v_sub_f32 v46, v46, v44
    v_cvt_pk_bf16_f32 v166, v166, v47
    v_cvt_pk_bf16_f32 v46, 0, v46
    v_or_b32 v246, v246, v46
    v_cmp_lt_i32 vcc, 27, v14
    s_nop 0
    s_cmp_eq_u64 vcc, 0
    s_cbranch_scc1 L_g1skip
    v_bfe_u32 v167, v251, 24, 8
    v_cmp_lt_i32 vcc, 27, v14
    v_lshrrev_b32 v247, 17, v67
    v_and_b32 v151, 0x1ffff, v67
    v_and_b32 v67, 15, v167
    v_lshl_add_u32 v67, v67, 2, s68
    s_mov_b64 exec, vcc
    ds_add_rtn_u32 v67, v67, v17
    s_mov_b64 exec, -1
    v_add_u32 v151, v151, v15
    v_mul_u32_u24 v48, 6, v247
    v_lshl_add_u32 v50, v167, 3, s77
    v_lshlrev_b32 v75, 3, v48
    v_and_b32 v48, -4, v48
    v_cmp_lt_i32 vcc, 27, v14
    s_nop 0
    s_mov_b64 exec, vcc
    ds_read2_b32 v[48:49], v48 offset0:0 offset1:1
    ds_read_b64 v[50:51], v50
    s_mov_b64 exec, -1
    s_waitcnt lgkmcnt(0)
    v_alignbit_b32 v48, v49, v48, v75
    v_lshrrev_b32 v49, v75, v49
    v_lshlrev_b32 v51, 16, v51
    v_lshlrev_b32 v49, 16, v49
    v_and_b32 v167, 0xffff0000, v50
    v_and_b32 v75, 0xffff0000, v48
    v_lshlrev_b32 v50, 16, v50
    v_lshlrev_b32 v48, 16, v48
    v_sub_f32 v51, v51, v49
    v_sub_f32 v167, v167, v75
    v_sub_f32 v50, v50, v48
    v_cvt_pk_bf16_f32 v167, v167, v51
    v_cvt_pk_bf16_f32 v50, 0, v50
    v_or_b32 v247, v247, v50
L_g1skip:
    s_waitcnt lgkmcnt(0)
    s_barrier
    v_and_b32 v28, 15, v12
    v_lshl_add_u32 v29, v28, 2, s68
    v_mov_b32 v31, 161856
    ds_read_b32 v30, v29
    ds_read_b32 v31, v31
    v_cmp_lt_i32 vcc, 0, v14
    s_nop 0
    s_mov_b64 exec, vcc
    ds_write_b32 v52, v136
    ds_write_b32 v52, v152 offset:16640
    ds_write_b32 v52, v232 offset:33280
    s_mov_b64 exec, -1
    v_cmp_lt_i32 vcc, 1, v14
    s_nop 0
    s_mov_b64 exec, vcc
    ds_write_b32 v53, v137
    ds_write_b32 v53, v153 offset:16640
    ds_write_b32 v53, v233 offset:33280
    s_mov_b64 exec, -1
    s_lshl_b32 s4, s3, 10
    s_add_u32 m0, s4, 32768
    s_add_u32 s5, s4, 8192
    buffer_load_dwordx4 v16, s[36:39], s4 offen lds
    s_add_u32 m0, s4, 132096
    s_lshl_b32 s69, s3, 11
    buffer_load_dwordx4 v16, s[52:55], s4 offen lds
    s_add_u32 m0, s4, 140288
    v_add_u32 v32, s69, v16
    buffer_load_dwordx4 v16, s[52:55], s5 offen lds
    v_add_u32 v32, 115712, v32
    v_mov_b32 v36, 0
    v_mov_b32 v37, 0
    v_mov_b32 v38, 0
    v_mov_b32 v39, 0
    ds_write_b128 v32, v[36:39]
    ds_write_b128 v32, v[36:39] offset:1024
    v_min_u32 v34, 2, v28
    v_lshlrev_b32 v34, 7, v34
    v_lshl_add_u32 v34, v28, 10, v34
    v_add_u32 v34, 65536, v34
    v_cmp_gt_u32 vcc, 2, v28
    v_mov_b32 v35, 1024
    v_mov_b32 v29, 1152
    v_cndmask_b32 v35, v35, v29, vcc
    s_waitcnt lgkmcnt(8)
    v_sub_u32 v30, v30, v34
    v_readfirstlane_b32 s73, v31
    v_cmp_gt_u32 vcc, v30, v35
    s_cmp_lg_u32 s64, 256
    s_cbranch_scc1 L_fits
    s_cmp_lg_u64 vcc, 0
    s_cselect_b32 s68, 1, s73
    s_cmp_eq_u32 s68, 0
    s_cbranch_scc1 L_fits
    s_mov_b32 s64, 8
    s_waitcnt vmcnt(0) lgkmcnt(0)
    s_branch L_batch
L_fits:
    s_cmp_lg_u32 s64, 256
    s_cbranch_scc1 L_nobal
    v_lshl_add_u32 v29, v30, 4, v28
    v_mov_b32 v31, 0
    s_nop 0
    v_sub_co_u32_dpp v33, vcc, v29, v29 row_ror:1 row_mask:0xf bank_mask:0xf
    s_nop 1
    v_addc_co_u32 v31, vcc, 0, v31, vcc
    v_sub_co_u32_dpp v33, vcc, v29, v29 row_ror:2 row_mask:0xf bank_mask:0xf
    s_nop 1
    v_addc_co_u32 v31, vcc, 0, v31, vcc
    v_sub_co_u32_dpp v33, vcc, v29, v29 row_ror:3 row_mask:0xf bank_mask:0xf
    s_nop 1
    v_addc_co_u32 v31, vcc, 0, v31, vcc
    v_sub_co_u32_dpp v33, vcc, v29, v29 row_ror:4 row_mask:0xf bank_mask:0xf
    s_nop 1
    v_addc_co_u32 v31, vcc, 0, v31, vcc
    v_sub_co_u32_dpp v33, vcc, v29, v29 row_ror:5 row_mask:0xf bank_mask:0xf
    s_nop 1
    v_addc_co_u32 v31, vcc, 0, v31, vcc
    v_sub_co_u32_dpp v33, vcc, v29, v29 row_ror:6 row_mask:0xf bank_mask:0xf
    s_nop 1
    v_addc_co_u32 v31, vcc, 0, v31, vcc
    v_sub_co_u32_dpp v33, vcc, v29, v29 row_ror:7 row_mask:0xf bank_mask:0xf
    s_nop 1
    v_addc_co_u32 v31, vcc, 0, v31, vcc
    v_sub_co_u32_dpp v33, vcc, v29, v29 row_ror:8 row_mask:0xf bank_mask:0xf
    s_nop 1
    v_addc_co_u32 v31, vcc, 0, v31, vcc
    v_sub_co_u32_dpp v33, vcc, v29, v29 row_ror:9 row_mask:0xf bank_mask:0xf
    s_nop 1
    v_addc_co_u32 v31, vcc, 0, v31, vcc
    v_sub_co_u32_dpp v33, vcc, v29, v29 row_ror:10 row_mask:0xf bank_mask:0xf
    s_nop 1
    v_addc_co_u32 v31, vcc, 0, v31, vcc
    v_sub_co_u32_dpp v33, vcc, v29, v29 row_ror:11 row_mask:0xf bank_mask:0xf
    s_nop 1
    v_addc_co_u32 v31, vcc, 0, v31, vcc
    v_sub_co_u32_dpp v33, vcc, v29, v29 row_ror:12 row_mask:0xf bank_mask:0xf
    s_nop 1
    v_addc_co_u32 v31, vcc, 0, v31, vcc
    v_sub_co_u32_dpp v33, vcc, v29, v29 row_ror:13 row_mask:0xf bank_mask:0xf
    s_nop 1
    v_addc_co_u32 v31, vcc, 0, v31, vcc
    v_sub_co_u32_dpp v33, vcc, v29, v29 row_ror:14 row_mask:0xf bank_mask:0xf
    s_nop 1
    v_addc_co_u32 v31, vcc, 0, v31, vcc
    v_sub_co_u32_dpp v33, vcc, v29, v29 row_ror:15 row_mask:0xf bank_mask:0xf
    s_nop 1
    v_addc_co_u32 v31, vcc, 0, v31, vcc
    s_sub_u32 s68, 11, s3
    s_cmp_lt_u32 s3, 4
    s_cselect_b32 s68, s3, s68
    s_sub_u32 s69, 15, s68
    v_cmp_eq_u32 vcc, s68, v31
    v_cmp_eq_u32 s[4:5], s69, v31
    s_nop 0
    s_ff1_i32_b32 s78, vcc_lo
    s_ff1_i32_b32 s79, s4
L_nobal:
    v_and_b32 v20, 7, v12
    v_bfe_u32 v21, v12, 3, 1
    s_sub_u32 s4, s79, s78
    s_add_u32 s69, s61, s78
    v_lshl_add_u32 v20, v20, 4, s69
    v_mad_i32_i24 v20, v21, s4, v20
    v_lshl_add_u32 v20, v20, 7, v9
    s_mov_b32 exec_lo, 0xffff
    s_mov_b32 exec_hi, 0xffff
    buffer_load_dwordx4 v[120:123], v20, s[16:19], 0 offen offset:0
    buffer_load_dwordx4 v[124:127], v20, s[16:19], 0 offen offset:32
    buffer_load_dwordx4 v[128:131], v20, s[16:19], 0 offen offset:64
    buffer_load_dwordx4 v[132:135], v20, s[16:19], 0 offen offset:96
    s_mov_b64 exec, -1
    v_readlane_b32 s4, v30, s78
    v_readlane_b32 s5, v34, s78
    v_readlane_b32 s6, v30, s79
    v_readlane_b32 s81, v34, s79
    v_cmp_lt_i32 vcc, 2, v14
    s_nop 0
    s_mov_b64 exec, vcc
    ds_write_b32 v54, v138
    ds_write_b32 v54, v154 offset:16640
    ds_write_b32 v54, v234 offset:33280
    s_mov_b64 exec, -1
    v_cmp_lt_i32 vcc, 3, v14
    s_nop 0
    s_mov_b64 exec, vcc
    ds_write_b32 v55, v139
    ds_write_b32 v55, v155 offset:16640
    ds_write_b32 v55, v235 offset:33280
    s_mov_b64 exec, -1
    v_cmp_lt_i32 vcc, 8, v14
    s_nop 0
    s_mov_b64 exec, vcc
    ds_write_b32 v56, v140
    ds_write_b32 v56, v156 offset:16640
    ds_write_b32 v56, v236 offset:33280
    s_mov_b64 exec, -1
    v_cmp_lt_i32 vcc, 9, v14
    s_nop 0
    s_mov_b64 exec, vcc
    ds_write_b32 v57, v141
    ds_write_b32 v57, v157 offset:16640
    ds_write_b32 v57, v237 offset:33280
    s_mov_b64 exec, -1
    v_cmp_lt_i32 vcc, 10, v14
    s_nop 0
    s_mov_b64 exec, vcc
    ds_write_b32 v58, v142
    ds_write_b32 v58, v158 offset:16640
    ds_write_b32 v58, v238 offset:33280
    s_mov_b64 exec, -1
    v_cmp_lt_i32 vcc, 11, v14
    s_nop 0
    s_mov_b64 exec, vcc
    ds_write_b32 v59, v143
    ds_write_b32 v59, v159 offset:16640
    ds_write_b32 v59, v239 offset:33280
    s_mov_b64 exec, -1
    v_cmp_lt_i32 vcc, 16, v14
    s_nop 0
    s_cmp_eq_u64 vcc, 0
    s_cbranch_scc1 L_g1skip2
    s_mov_b64 exec, vcc
    ds_write_b32 v60, v144
    ds_write_b32 v60, v160 offset:16640
    ds_write_b32 v60, v240 offset:33280
    s_mov_b64 exec, -1
    v_cmp_lt_i32 vcc, 17, v14
    s_nop 0
    s_cmp_eq_u64 vcc, 0
    s_cbranch_scc1 L_g1skip2
    s_mov_b64 exec, vcc
    ds_write_b32 v61, v145
    ds_write_b32 v61, v161 offset:16640
    ds_write_b32 v61, v241 offset:33280
    s_mov_b64 exec, -1
    v_cmp_lt_i32 vcc, 18, v14
    s_nop 0
    s_cmp_eq_u64 vcc, 0
    s_cbranch_scc1 L_g1skip2
    s_mov_b64 exec, vcc
    ds_write_b32 v62, v146
    ds_write_b32 v62, v162 offset:16640
    ds_write_b32 v62, v242 offset:33280
    s_mov_b64 exec, -1
    v_cmp_lt_i32 vcc, 19, v14
    s_nop 0
    s_cmp_eq_u64 vcc, 0
    s_cbranch_scc1 L_g1skip2
    s_mov_b64 exec, vcc
    ds_write_b32 v63, v147
    ds_write_b32 v63, v163 offset:16640
    ds_write_b32 v63, v243 offset:33280
    s_mov_b64 exec, -1
    v_cmp_lt_i32 vcc, 24, v14
    s_nop 0
    s_cmp_eq_u64 vcc, 0
    s_cbranch_scc1 L_g1skip2
    s_mov_b64 exec, vcc
    ds_write_b32 v64, v148
    ds_write_b32 v64, v164 offset:16640
    ds_write_b32 v64, v244 offset:33280
    s_mov_b64 exec, -1
    v_cmp_lt_i32 vcc, 25, v14
    s_nop 0
    s_cmp_eq_u64 vcc, 0
    s_cbranch_scc1 L_g1skip2
    s_mov_b64 exec, vcc
    ds_write_b32 v65, v149
    ds_write_b32 v65, v165 offset:16640
    ds_write_b32 v65, v245 offset:33280
    s_mov_b64 exec, -1
    v_cmp_lt_i32 vcc, 26, v14
    s_nop 0
    s_cmp_eq_u64 vcc, 0
    s_cbranch_scc1 L_g1skip2
    s_mov_b64 exec, vcc
    ds_write_b32 v66, v150
    ds_write_b32 v66, v166 offset:16640
    ds_write_b32 v66, v246 offset:33280
    s_mov_b64 exec, -1
    v_cmp_lt_i32 vcc, 27, v14
    s_nop 0
    s_cmp_eq_u64 vcc, 0
    s_cbranch_scc1 L_g1skip2
    s_mov_b64 exec, vcc
    ds_write_b32 v67, v151
    ds_write_b32 v67, v167 offset:16640
    ds_write_b32 v67, v247 offset:33280
    s_mov_b64 exec, -1
L_g1skip2:
    s_add_u32 s80, s4, 124
    s_lshr_b32 s80, s80, 7
    s_add_u32 s66, s6, 124
    s_lshr_b32 s66, s66, 7
    v_mov_b32 v28, s4
    v_mov_b32 v29, s6
    v_cndmask_b32 v28, v28, v29, s[8:9]
    v_mov_b32 v29, s5
    v_mov_b32 v30, s81
    v_cndmask_b32 v29, v29, v30, s[8:9]
    v_and_b32 v30, 31, v12
    v_add_u32 v31, 124, v28
    v_lshl_add_u32 v28, v30, 2, v28
    v_and_b32 v31, 0xffffff80, v31
    v_cmp_gt_u32 vcc, v31, v28
    v_add_u32 v29, v29, v28
    v_mov_b32 v30, 2147483644
    v_mov_b32 v31, 0xffff
    s_mov_b64 exec, vcc
    ds_write_b32 v29, v30
    ds_write_b32 v29, v0 offset:16640
    ds_write_b32 v29, v31 offset:33280
    s_mov_b64 exec, -1
    s_add_u32 s66, s66, s80
    s_sub_u32 s68, 255, s66
    v_mov_b32 v28, s68
    v_mov_b32 v29, 161860
    s_mov_b64 exec, 1
    ds_max_u32 v29, v28
    s_mov_b64 exec, -1
    s_cmp_eq_u32 s80, 0
    s_cselect_b32 s5, s81, s5
    s_add_u32 s83, s5, 128
    s_cmp_eq_u32 s80, 1
    s_cselect_b32 s83, s81, s83
    v_add_u32 v20, s5, v11
    v_add_u32 v21, s83, v11
    v_add_u32 v22, s5, v10
    v_add_u32 v23, s83, v10
    s_setprio 3
    s_waitcnt lgkmcnt(0)
    s_barrier
    ds_read_b32 v14, v20
    ds_read_b128 v[28:31], v22 offset:33280
    ds_read_b128 v[44:47], v23 offset:33280
    ds_read_b32 v27, v21
    ds_read_b32 v17, v20 offset:16640
    ds_read_b32 v16, v20 offset:33280
    v_mov_b32 v79, 161860
    ds_read_b32 v79, v79
    s_cmp_gt_u32 s66, 0
    s_cselect_b32 s4, 0, 2147483616
    s_cmp_gt_u32 s66, 1
    s_cselect_b32 s74, 0, 2147483616
    s_waitcnt lgkmcnt(5)
    v_mad_u32_u16 v28, v28, s70, v1
    v_mad_u32_u16 v29, v29, s70, v2
    v_mad_u32_u16 v30, v30, s70, v1
    v_mad_u32_u16 v31, v31, s70, v2
    v_and_or_b32 v24, v14, s71, v9
    s_add_u32 m0, s67, 0
    s_nop 0
    buffer_load_dwordx4 v28, s[16:19], s4 offen  lds
    s_add_u32 m0, s67, 1024
    s_nop 0
    buffer_load_dwordx4 v29, s[16:19], s4 offen  lds
    s_add_u32 m0, s67, 2048
    s_nop 0
    buffer_load_dwordx4 v30, s[16:19], s4 offen  lds
    s_add_u32 m0, s67, 3072
    s_nop 0
    buffer_load_dwordx4 v31, s[16:19], s4 offen  lds
    buffer_load_dwordx4 v[32:35], v24, s[24:27], s4 offen nt
    s_waitcnt vmcnt(9)
    s_barrier
    ds_read_b64_tr_b16 v[232:233], v76 offset:32768
    ds_read_b64_tr_b16 v[234:235], v76 offset:33280
    ds_read_b64_tr_b16 v[236:237], v76 offset:32832
    ds_read_b64_tr_b16 v[238:239], v76 offset:33344
    ds_read_b64_tr_b16 v[240:241], v76 offset:34816
    ds_read_b64_tr_b16 v[242:243], v76 offset:35328
    ds_read_b64_tr_b16 v[244:245], v76 offset:34880
    ds_read_b64_tr_b16 v[246:247], v76 offset:35392
    ds_read_b64_tr_b16 v[248:249], v76 offset:36864
    ds_read_b64_tr_b16 v[250:251], v76 offset:37376
    ds_read_b64_tr_b16 v[252:253], v76 offset:36928
    ds_read_b64_tr_b16 v[254:255], v76 offset:37440
    ds_read_b64_tr_b16 v[68:69], v76 offset:38912
    ds_read_b64_tr_b16 v[70:71], v76 offset:39424
    ds_read_b64_tr_b16 v[72:73], v76 offset:38976
    ds_read_b64_tr_b16 v[74:75], v76 offset:39488
    v_and_b32 v24, 31, v12
    v_lshlrev_b32 v24, 1, v24
    v_add_u32 v24, 158720, v24
    ds_read_u16_d16_hi v22, v24
    ds_read_u16_d16_hi v23, v24 offset:64
    s_waitcnt lgkmcnt(0)
    s_barrier
    v_mad_u32_u16 v44, v44, s70, v1
    v_mad_u32_u16 v45, v45, s70, v2
    v_mad_u32_u16 v46, v46, s70, v1
    v_mad_u32_u16 v47, v47, s70, v2
    v_and_or_b32 v27, v27, s71, v9
    v_readfirstlane_b32 s13, v79
    s_add_u32 m0, s67, 32768
    s_nop 0
    buffer_load_dwordx4 v44, s[16:19], s74 offen  lds
    s_add_u32 m0, s67, 33792
    s_nop 0
    buffer_load_dwordx4 v45, s[16:19], s74 offen  lds
    s_add_u32 m0, s67, 34816
    s_nop 0
    buffer_load_dwordx4 v46, s[16:19], s74 offen  lds
    s_add_u32 m0, s67, 35840
    s_nop 0
    buffer_load_dwordx4 v47, s[16:19], s74 offen  lds
    s_sub_u32 s13, 255, s13
    s_waitcnt vmcnt(9)
    v_mfma_f32_32x32x16_bf16 v[136:151], v[120:123], v[232:235], 0
    v_mfma_f32_32x32x16_bf16 v[152:167], v[120:123], v[236:239], 0
    v_mfma_f32_32x32x16_bf16 v[136:151], v[124:127], v[240:243], v[136:151]
    v_mfma_f32_32x32x16_bf16 v[152:167], v[124:127], v[244:247], v[152:167]
    v_mfma_f32_32x32x16_bf16 v[136:151], v[128:131], v[248:251], v[136:151]
    v_mfma_f32_32x32x16_bf16 v[152:167], v[128:131], v[252:255], v[152:167]
    v_mfma_f32_32x32x16_bf16 v[136:151], v[132:135], v[68:71], v[136:151]
    v_mfma_f32_32x32x16_bf16 v[152:167], v[132:135], v[72:75], v[152:167]
    v_mul_f32 v22, s75, v22
    v_cvt_pk_bf16_f32 v24, 0, v22
    v_sub_f32 v22, v22, v24
    v_cvt_pk_bf16_f32 v22, 0, v22
    v_cndmask_b32 v22, v24, v22, s[8:9]
    v_mul_f32 v23, s75, v23
    v_cvt_pk_bf16_f32 v24, 0, v23
    v_sub_f32 v23, v23, v24
    v_cvt_pk_bf16_f32 v23, 0, v23
    v_cndmask_b32 v23, v24, v23, s[8:9]
    s_nop 1
    v_mul_f32 v136, s75, v136
    v_mul_f32 v137, s75, v137
    v_mul_f32 v138, s75, v138
    v_mul_f32 v139, s75, v139
    v_cvt_pk_bf16_f32 v120, v136, v137
    v_lshlrev_b32 v24, 16, v120
    v_and_b32 v25, 0xffff0000, v120
    v_sub_f32 v24, v136, v24
    v_sub_f32 v25, v137, v25
    v_cvt_pk_bf16_f32 v122, v24, v25
    v_cvt_pk_bf16_f32 v121, v138, v139
    v_lshlrev_b32 v24, 16, v121
    v_and_b32 v25, 0xffff0000, v121
    v_sub_f32 v24, v138, v24
    v_sub_f32 v25, v139, v25
    v_cvt_pk_bf16_f32 v123, v24, v25
    s_nop 1
    v_permlane32_swap_b32 v120, v122
    v_permlane32_swap_b32 v121, v123
    s_nop 0
    v_and_b32 v123, 0xffff, v123
    v_or_b32 v123, v123, v22
    v_mul_f32 v152, s75, v152
    v_mul_f32 v153, s75, v153
    v_mul_f32 v154, s75, v154
    v_mul_f32 v155, s75, v155
    v_cvt_pk_bf16_f32 v124, v152, v153
    v_lshlrev_b32 v24, 16, v124
    v_and_b32 v25, 0xffff0000, v124
    v_sub_f32 v24, v152, v24
    v_sub_f32 v25, v153, v25
    v_cvt_pk_bf16_f32 v126, v24, v25
    v_cvt_pk_bf16_f32 v125, v154, v155
    v_lshlrev_b32 v24, 16, v125
    v_and_b32 v25, 0xffff0000, v125
    v_sub_f32 v24, v154, v24
    v_sub_f32 v25, v155, v25
    v_cvt_pk_bf16_f32 v127, v24, v25
    s_nop 1
    v_permlane32_swap_b32 v124, v126
    v_permlane32_swap_b32 v125, v127
    s_nop 0
    v_and_b32 v127, 0xffff, v127
    v_or_b32 v127, v127, v23
    v_mul_f32 v140, s75, v140
    v_mul_f32 v141, s75, v141
    v_mul_f32 v142, s75, v142
    v_mul_f32 v143, s75, v143
    v_cvt_pk_bf16_f32 v128, v140, v141
    v_lshlrev_b32 v24, 16, v128
    v_and_b32 v25, 0xffff0000, v128
    v_sub_f32 v24, v140, v24
    v_sub_f32 v25, v141, v25
    v_cvt_pk_bf16_f32 v130, v24, v25
    v_cvt_pk_bf16_f32 v129, v142, v143
    v_lshlrev_b32 v24, 16, v129
    v_and_b32 v25, 0xffff0000, v129
    v_sub_f32 v24, v142, v24
    v_sub_f32 v25, v143, v25
    v_cvt_pk_bf16_f32 v131, v24, v25
    s_nop 1
    v_permlane32_swap_b32 v128, v130
    v_permlane32_swap_b32 v129, v131
    s_nop 0
    v_and_b32 v131, 0xffff, v131
    v_or_b32 v131, v131, v22
    v_mul_f32 v156, s75, v156
    v_mul_f32 v157, s75, v157
    v_mul_f32 v158, s75, v158
    v_mul_f32 v159, s75, v159
    v_cvt_pk_bf16_f32 v132, v156, v157
    v_lshlrev_b32 v24, 16, v132
    v_and_b32 v25, 0xffff0000, v132
    v_sub_f32 v24, v156, v24
    v_sub_f32 v25, v157, v25
    v_cvt_pk_bf16_f32 v134, v24, v25
    v_cvt_pk_bf16_f32 v133, v158, v159
    v_lshlrev_b32 v24, 16, v133
    v_and_b32 v25, 0xffff0000, v133
    v_sub_f32 v24, v158, v24
    v_sub_f32 v25, v159, v25
    v_cvt_pk_bf16_f32 v135, v24, v25
    s_nop 1
    v_permlane32_swap_b32 v132, v134
    v_permlane32_swap_b32 v133, v135
    s_nop 0
    v_and_b32 v135, 0xffff, v135
    v_or_b32 v135, v135, v23
    s_mov_b32 s82, 0
    s_cmp_eq_u32 s66, 0
    s_cbranch_scc1 L_tail
    v_mov_b32 v160, 0
    v_mov_b32 v48, 0
    v_mov_b32 v161, 0
    v_mov_b32 v49, 0
    v_mov_b32 v162, 0
    v_mov_b32 v50, 0
    v_mov_b32 v163, 0
    v_mov_b32 v51, 0
    v_and_b32 v14, 31, v14
    v_lshl_add_u32 v25, v14, 2, s72
    ds_read_b128 v[40:43], v25
    v_and_b32 v22, 0xffff0000, v16
    v_lshlrev_b32 v23, 16, v17
    v_and_b32 v24, 0xffff0000, v17
    v_or_b32 v16, 0x3f80, v22
    v_mul_f32 v22, v22, v22
    v_mul_f32 v23, v23, v23
    v_mul_f32 v24, v24, v24
    v_cvt_pk_bf16_f32 v22, 0, v22
    v_cvt_pk_bf16_f32 v23, 0, v23
    v_cvt_pk_bf16_f32 v24, 0, v24
    v_lshl_add_u32 v14, v14, 1, v7
    v_add_f32 v22, v22, v23
    v_add_f32 v22, v22, v24
    v_cvt_pk_bf16_f32 v22, 0, v22
    s_waitcnt lgkmcnt(0)
    v_or_b32 v43, v43, v22
    s_waitcnt vmcnt(4)
    ds_read_b128 v[52:55], v3 offset:0
    ds_read_b128 v[56:59], v4 offset:0
    ds_read_b128 v[60:63], v5 offset:0
    ds_read_b128 v[64:67], v6 offset:0
    buffer_load_dwordx4 v[36:39], v27, s[24:27], s74 offen nt
    s_cmp_lg_u32 s82, s80
    s_cbranch_scc1 L_noxbh
    v_swap_b32 v120, v128
    v_swap_b32 v121, v129
    v_swap_b32 v122, v130
    v_swap_b32 v123, v131
    v_swap_b32 v124, v132
    v_swap_b32 v125, v133
    v_swap_b32 v126, v134
    v_swap_b32 v127, v135
L_noxbh:
    s_add_u32 s83, s83, 128
    s_add_u32 s68, s82, 2
    s_cmp_eq_u32 s68, s80
    s_cselect_b32 s83, s81, s83
    s_cmp_lt_u32 s68, s66
    s_cselect_b32 s74, 0, 2147483616
    v_add_u32 v26, s83, v10
    v_add_u32 v20, s83, v11
    ds_read_b128 v[28:31], v26 offset:33280
    ds_read_b32 v27, v20
    v_mfma_f32_32x32x16_bf16 v[136:151], v[40:43], v[120:123], 0
    ds_read_b32 v15, v21
    ds_read_b32 v19, v21 offset:16640
    ds_read_b32 v18, v21 offset:33280
    s_waitcnt lgkmcnt(8)
    v_mfma_f32_32x32x16_bf16 v[136:151], v[52:55], v[80:83], v[136:151]
    s_waitcnt lgkmcnt(3)
    v_mad_u32_u16 v28, v28, s70, v1
    v_mad_u32_u16 v29, v29, s70, v2
    v_mad_u32_u16 v30, v30, s70, v1
    v_mad_u32_u16 v31, v31, s70, v2
    v_mfma_f32_32x32x16_bf16 v[136:151], v[56:59], v[88:91], v[136:151]
    v_and_or_b32 v27, v27, s71, v9
    v_mfma_f32_32x32x16_bf16 v[136:151], v[60:63], v[96:99], v[136:151]
    v_mfma_f32_32x32x16_bf16 v[136:151], v[64:67], v[104:107], v[136:151]
    s_waitcnt vmcnt(5)
    v_mfma_f32_32x32x16_bf16 v[136:151], v[32:35], v[112:115], v[136:151]
    s_nop 7
    s_nop 1
    s_branch L_ph2
L_tile:
    buffer_load_dwordx4 v[36:39], v27, s[24:27], s74 offen nt
    s_cmp_lg_u32 s82, s80
    s_cbranch_scc1 L_noxb0
    v_swap_b32 v120, v128
    v_swap_b32 v121, v129
    v_swap_b32 v122, v130
    v_swap_b32 v123, v131
    v_swap_b32 v124, v132
    v_swap_b32 v125, v133
    v_swap_b32 v126, v134
    v_swap_b32 v127, v135
L_noxb0:
    s_add_u32 s83, s83, 128
    s_add_u32 s68, s82, 2
    s_cmp_eq_u32 s68, s80
    s_cselect_b32 s83, s81, s83
    s_cmp_lt_u32 s68, s66
    s_cselect_b32 s74, 0, 2147483616
    v_add_u32 v26, s83, v10
    v_add_u32 v20, s83, v11
    ds_read_b128 v[28:31], v26 offset:33280
    ds_read_b32 v27, v20
    v_mfma_f32_32x32x16_bf16 v[168:183], v[144:147], v[48:51], v[168:183]
    v_exp_f32 v68, v152
    v_exp_f32 v69, v153
    v_exp_f32 v70, v154
    v_exp_f32 v71, v155
    v_pk_add_f32 v[68:69], v[68:69], 1.0 op_sel_hi:[1,0]
    v_pk_add_f32 v[70:71], v[70:71], 1.0 op_sel_hi:[1,0]
    v_mfma_f32_32x32x16_bf16 v[136:151], v[40:43], v[120:123], 0
    v_rcp_f32 v68, v68
    v_rcp_f32 v69, v69
    v_rcp_f32 v70, v70
    v_rcp_f32 v71, v71
    v_pk_mul_f32 v[68:69], v[152:153], v[68:69]
    v_pk_mul_f32 v[70:71], v[154:155], v[70:71]
    v_cvt_pk_bf16_f32 v152, v68, v69
    v_cvt_pk_bf16_f32 v153, v70, v71
    ds_read_b32 v15, v21
    ds_read_b32 v19, v21 offset:16640
    ds_read_b32 v18, v21 offset:33280
    s_waitcnt lgkmcnt(8)
    v_mfma_f32_32x32x16_bf16 v[136:151], v[52:55], v[80:83], v[136:151]
    v_exp_f32 v72, v156
    v_exp_f32 v73, v157
    v_exp_f32 v74, v158
    v_exp_f32 v75, v159
    v_pk_add_f32 v[72:73], v[72:73], 1.0 op_sel_hi:[1,0]
    v_pk_add_f32 v[74:75], v[74:75], 1.0 op_sel_hi:[1,0]
    s_waitcnt lgkmcnt(3)
    v_mad_u32_u16 v28, v28, s70, v1
    v_mad_u32_u16 v29, v29, s70, v2
    v_mad_u32_u16 v30, v30, s70, v1
    v_mad_u32_u16 v31, v31, s70, v2
    v_mfma_f32_32x32x16_bf16 v[136:151], v[56:59], v[88:91], v[136:151]
    v_rcp_f32 v72, v72
    v_rcp_f32 v73, v73
    v_rcp_f32 v74, v74
    v_rcp_f32 v75, v75
    v_pk_mul_f32 v[72:73], v[156:157], v[72:73]
    v_pk_mul_f32 v[74:75], v[158:159], v[74:75]
    v_cvt_pk_bf16_f32 v154, v72, v73
    v_cvt_pk_bf16_f32 v155, v74, v75
    v_and_or_b32 v27, v27, s71, v9
    v_mfma_f32_32x32x16_bf16 v[136:151], v[60:63], v[96:99], v[136:151]
    v_exp_f32 v68, v160
    v_exp_f32 v69, v161
    v_exp_f32 v70, v162
    v_exp_f32 v71, v163
    v_pk_add_f32 v[68:69], v[68:69], 1.0 op_sel_hi:[1,0]
    v_pk_add_f32 v[70:71], v[70:71], 1.0 op_sel_hi:[1,0]
    v_mfma_f32_32x32x16_bf16 v[136:151], v[64:67], v[104:107], v[136:151]
    v_rcp_f32 v68, v68
    v_rcp_f32 v69, v69
    v_rcp_f32 v70, v70
    v_rcp_f32 v71, v71
    v_pk_mul_f32 v[68:69], v[160:161], v[68:69]
    v_pk_mul_f32 v[70:71], v[162:163], v[70:71]
    v_cvt_pk_bf16_f32 v160, v68, v69
    v_cvt_pk_bf16_f32 v161, v70, v71
    s_waitcnt vmcnt(5)
    v_mfma_f32_32x32x16_bf16 v[136:151], v[32:35], v[112:115], v[136:151]
    v_exp_f32 v72, v164
    v_exp_f32 v73, v165
    v_exp_f32 v74, v166
    v_exp_f32 v75, v167
    v_pk_add_f32 v[72:73], v[72:73], 1.0 op_sel_hi:[1,0]
    v_pk_add_f32 v[74:75], v[74:75], 1.0 op_sel_hi:[1,0]
    v_mfma_f32_32x32x16_bf16 v[184:199], v[152:155], v[44:47], v[184:199]
    v_rcp_f32 v72, v72
    v_rcp_f32 v73, v73
    v_rcp_f32 v74, v74
    v_rcp_f32 v75, v75
    v_pk_mul_f32 v[72:73], v[164:165], v[72:73]
    v_pk_mul_f32 v[74:75], v[166:167], v[74:75]
    v_cvt_pk_bf16_f32 v162, v72, v73
    v_cvt_pk_bf16_f32 v163, v74, v75
L_ph2:
    s_add_u32 s82, s82, 1
    s_nop 0
    v_mfma_f32_32x32x16_bf16 v[184:199], v[160:163], v[48:51], v[184:199]
    v_exp_f32 v68, v136
    v_exp_f32 v69, v137
    v_exp_f32 v70, v138
    v_exp_f32 v71, v139
    v_pk_add_f32 v[68:69], v[68:69], 1.0 op_sel_hi:[1,0]
    v_pk_add_f32 v[70:71], v[70:71], 1.0 op_sel_hi:[1,0]
    v_mfma_f32_32x32x16_bf16 v[152:167], v[40:43], v[124:127], 0
    v_rcp_f32 v68, v68
    v_rcp_f32 v69, v69
    v_rcp_f32 v70, v70
    v_rcp_f32 v71, v71
    v_pk_mul_f32 v[68:69], v[136:137], v[68:69]
    v_pk_mul_f32 v[70:71], v[138:139], v[70:71]
    v_cvt_pk_bf16_f32 v136, v68, v69
    v_cvt_pk_bf16_f32 v137, v70, v71
    s_mov_b64 exec, s[10:11]
    ds_write_b64 v14, v[16:17]
    s_mov_b64 exec, -1
    ds_read_b64_tr_b16 v[44:45], v8
    ds_read_b64_tr_b16 v[46:47], v8 offset:512
    ds_read_b64_tr_b16 v[48:49], v8 offset:1024
    ds_read_b64_tr_b16 v[50:51], v8 offset:1536
    s_mov_b64 exec, s[10:11]
    ds_write2_b32 v14, v0, v0 offset0:0 offset1:1
    s_mov_b64 exec, -1
    s_waitcnt lgkmcnt(6)
    v_and_b32 v15, 31, v15
    v_lshl_add_u32 v25, v15, 2, s72
    ds_read_b128 v[40:43], v25
    v_and_b32 v22, 0xffff0000, v18
    v_lshlrev_b32 v23, 16, v19
    v_and_b32 v24, 0xffff0000, v19
    v_mfma_f32_32x32x16_bf16 v[152:167], v[32:35], v[116:119], v[152:167]
    v_exp_f32 v72, v140
    v_exp_f32 v73, v141
    v_exp_f32 v74, v142
    v_exp_f32 v75, v143
    v_pk_add_f32 v[72:73], v[72:73], 1.0 op_sel_hi:[1,0]
    v_pk_add_f32 v[74:75], v[74:75], 1.0 op_sel_hi:[1,0]
    v_or_b32 v18, 0x3f80, v22
    v_mul_f32 v22, v22, v22
    v_mul_f32 v23, v23, v23
    v_mul_f32 v24, v24, v24
    s_add_u32 m0, s67, 0
    v_mfma_f32_32x32x16_bf16 v[152:167], v[52:55], v[84:87], v[152:167]
    buffer_load_dwordx4 v28, s[16:19], s74 offen  lds
    v_rcp_f32 v72, v72
    v_rcp_f32 v73, v73
    v_rcp_f32 v74, v74
    v_rcp_f32 v75, v75
    v_pk_mul_f32 v[72:73], v[140:141], v[72:73]
    v_pk_mul_f32 v[74:75], v[142:143], v[74:75]
    v_cvt_pk_bf16_f32 v138, v72, v73
    v_cvt_pk_bf16_f32 v139, v74, v75
    v_cvt_pk_bf16_f32 v22, 0, v22
    v_cvt_pk_bf16_f32 v23, 0, v23
    v_cvt_pk_bf16_f32 v24, 0, v24
    v_lshl_add_u32 v15, v15, 1, v7
    s_add_u32 m0, s67, 1024
    v_mfma_f32_32x32x16_bf16 v[152:167], v[56:59], v[92:95], v[152:167]
    buffer_load_dwordx4 v29, s[16:19], s74 offen  lds
    v_exp_f32 v68, v144
    v_exp_f32 v69, v145
    v_exp_f32 v70, v146
    v_exp_f32 v71, v147
    v_pk_add_f32 v[68:69], v[68:69], 1.0 op_sel_hi:[1,0]
    v_pk_add_f32 v[70:71], v[70:71], 1.0 op_sel_hi:[1,0]
    s_sub_u32 s68, s82, 1
    s_cmp_lg_u32 s68, s80
    s_cbranch_scc1 L_noacc0
    v_swap_b32 v168, v200
    v_swap_b32 v169, v201
    v_swap_b32 v170, v202
    v_swap_b32 v171, v203
    v_swap_b32 v172, v204
    v_swap_b32 v173, v205
    v_swap_b32 v174, v206
    v_swap_b32 v175, v207
    v_swap_b32 v176, v208
    v_swap_b32 v177, v209
    v_swap_b32 v178, v210
    v_swap_b32 v179, v211
    v_swap_b32 v180, v212
    v_swap_b32 v181, v213
    v_swap_b32 v182, v214
    v_swap_b32 v183, v215
    v_swap_b32 v184, v216
    v_swap_b32 v185, v217
    v_swap_b32 v186, v218
    v_swap_b32 v187, v219
    v_swap_b32 v188, v220
    v_swap_b32 v189, v221
    v_swap_b32 v190, v222
    v_swap_b32 v191, v223
    v_swap_b32 v192, v224
    v_swap_b32 v193, v225
    v_swap_b32 v194, v226
    v_swap_b32 v195, v227
    v_swap_b32 v196, v228
    v_swap_b32 v197, v229
    v_swap_b32 v198, v230
    v_swap_b32 v199, v231
L_noacc0:
    v_add_f32 v22, v22, v23
    v_add_f32 v22, v22, v24
    v_cvt_pk_bf16_f32 v22, 0, v22
    s_waitcnt lgkmcnt(0)
    v_or_b32 v43, v43, v22
    s_add_u32 m0, s67, 2048
    v_mfma_f32_32x32x16_bf16 v[152:167], v[60:63], v[100:103], v[152:167]
    buffer_load_dwordx4 v30, s[16:19], s74 offen  lds
    v_rcp_f32 v68, v68
    v_rcp_f32 v69, v69
    v_rcp_f32 v70, v70
    v_rcp_f32 v71, v71
    v_pk_mul_f32 v[68:69], v[144:145], v[68:69]
    v_pk_mul_f32 v[70:71], v[146:147], v[70:71]
    v_cvt_pk_bf16_f32 v144, v68, v69
    v_cvt_pk_bf16_f32 v145, v70, v71
    s_add_u32 m0, s67, 3072
    v_mfma_f32_32x32x16_bf16 v[152:167], v[64:67], v[108:111], v[152:167]
    buffer_load_dwordx4 v31, s[16:19], s74 offen  lds
    v_exp_f32 v72, v148
    v_exp_f32 v73, v149
    v_exp_f32 v74, v150
    v_exp_f32 v75, v151
    v_pk_add_f32 v[72:73], v[72:73], 1.0 op_sel_hi:[1,0]
    v_pk_add_f32 v[74:75], v[74:75], 1.0 op_sel_hi:[1,0]
    s_sub_u32 s68, s66, s82
    s_cmp_gt_u32 s68, 3
    s_cbranch_scc1 L_pr0
    s_setprio 2
    s_cmp_gt_u32 s68, 1
    s_cbranch_scc1 L_pr0
    s_setprio 1
    s_cmp_gt_u32 s68, 0
    s_cbranch_scc1 L_pr0
    s_setprio 0
L_pr0:
    s_waitcnt vmcnt(5)
    ds_read_b128 v[52:55], v3 offset:32768
    ds_read_b128 v[56:59], v4 offset:32768
    ds_read_b128 v[60:63], v5 offset:32768
    ds_read_b128 v[64:67], v6 offset:32768
    v_mfma_f32_32x32x16_bf16 v[168:183], v[136:139], v[44:47], v[168:183]
    v_rcp_f32 v72, v72
    v_rcp_f32 v73, v73
    v_rcp_f32 v74, v74
    v_rcp_f32 v75, v75
    v_pk_mul_f32 v[72:73], v[148:149], v[72:73]
    v_pk_mul_f32 v[74:75], v[150:151], v[74:75]
    v_cvt_pk_bf16_f32 v146, v72, v73
    v_cvt_pk_bf16_f32 v147, v74, v75
    s_cmp_lg_u32 s82, s66
    s_cbranch_scc0 L_tail
    buffer_load_dwordx4 v[32:35], v27, s[24:27], s74 offen nt
    s_cmp_lg_u32 s82, s80
    s_cbranch_scc1 L_noxb1
    v_swap_b32 v120, v128
    v_swap_b32 v121, v129
    v_swap_b32 v122, v130
    v_swap_b32 v123, v131
    v_swap_b32 v124, v132
    v_swap_b32 v125, v133
    v_swap_b32 v126, v134
    v_swap_b32 v127, v135
L_noxb1:
    s_add_u32 s83, s83, 128
    s_add_u32 s68, s82, 2
    s_cmp_eq_u32 s68, s80
    s_cselect_b32 s83, s81, s83
    s_cmp_lt_u32 s68, s66
    s_cselect_b32 s74, 0, 2147483616
    v_add_u32 v26, s83, v10
    v_add_u32 v21, s83, v11
    ds_read_b128 v[28:31], v26 offset:33280
    ds_read_b32 v27, v21
    v_mfma_f32_32x32x16_bf16 v[168:183], v[144:147], v[48:51], v[168:183]
    v_exp_f32 v68, v152
    v_exp_f32 v69, v153
    v_exp_f32 v70, v154
    v_exp_f32 v71, v155
    v_pk_add_f32 v[68:69], v[68:69], 1.0 op_sel_hi:[1,0]
    v_pk_add_f32 v[70:71], v[70:71], 1.0 op_sel_hi:[1,0]
    v_mfma_f32_32x32x16_bf16 v[136:151], v[40:43], v[120:123], 0
    v_rcp_f32 v68, v68
    v_rcp_f32 v69, v69
    v_rcp_f32 v70, v70
    v_rcp_f32 v71, v71
    v_pk_mul_f32 v[68:69], v[152:153], v[68:69]
    v_pk_mul_f32 v[70:71], v[154:155], v[70:71]
    v_cvt_pk_bf16_f32 v152, v68, v69
    v_cvt_pk_bf16_f32 v153, v70, v71
    ds_read_b32 v14, v20
    ds_read_b32 v17, v20 offset:16640
    ds_read_b32 v16, v20 offset:33280
    s_waitcnt lgkmcnt(8)
    v_mfma_f32_32x32x16_bf16 v[136:151], v[52:55], v[80:83], v[136:151]
    v_exp_f32 v72, v156
    v_exp_f32 v73, v157
    v_exp_f32 v74, v158
    v_exp_f32 v75, v159
    v_pk_add_f32 v[72:73], v[72:73], 1.0 op_sel_hi:[1,0]
    v_pk_add_f32 v[74:75], v[74:75], 1.0 op_sel_hi:[1,0]
    s_waitcnt lgkmcnt(3)
    v_mad_u32_u16 v28, v28, s70, v1
    v_mad_u32_u16 v29, v29, s70, v2
    v_mad_u32_u16 v30, v30, s70, v1
    v_mad_u32_u16 v31, v31, s70, v2
    v_mfma_f32_32x32x16_bf16 v[136:151], v[56:59], v[88:91], v[136:151]
    v_rcp_f32 v72, v72
    v_rcp_f32 v73, v73
    v_rcp_f32 v74, v74
    v_rcp_f32 v75, v75
    v_pk_mul_f32 v[72:73], v[156:157], v[72:73]
    v_pk_mul_f32 v[74:75], v[158:159], v[74:75]
    v_cvt_pk_bf16_f32 v154, v72, v73
    v_cvt_pk_bf16_f32 v155, v74, v75
    v_and_or_b32 v27, v27, s71, v9
    v_mfma_f32_32x32x16_bf16 v[136:151], v[60:63], v[96:99], v[136:151]
    v_exp_f32 v68, v160
    v_exp_f32 v69, v161
    v_exp_f32 v70, v162
    v_exp_f32 v71, v163
    v_pk_add_f32 v[68:69], v[68:69], 1.0 op_sel_hi:[1,0]
    v_pk_add_f32 v[70:71], v[70:71], 1.0 op_sel_hi:[1,0]
    v_mfma_f32_32x32x16_bf16 v[136:151], v[64:67], v[104:107], v[136:151]
    v_rcp_f32 v68, v68
    v_rcp_f32 v69, v69
    v_rcp_f32 v70, v70
    v_rcp_f32 v71, v71
    v_pk_mul_f32 v[68:69], v[160:161], v[68:69]
    v_pk_mul_f32 v[70:71], v[162:163], v[70:71]
    v_cvt_pk_bf16_f32 v160, v68, v69
    v_cvt_pk_bf16_f32 v161, v70, v71
    s_waitcnt vmcnt(5)
    v_mfma_f32_32x32x16_bf16 v[136:151], v[36:39], v[112:115], v[136:151]
    v_exp_f32 v72, v164
    v_exp_f32 v73, v165
    v_exp_f32 v74, v166
    v_exp_f32 v75, v167
    v_pk_add_f32 v[72:73], v[72:73], 1.0 op_sel_hi:[1,0]
    v_pk_add_f32 v[74:75], v[74:75], 1.0 op_sel_hi:[1,0]
    v_mfma_f32_32x32x16_bf16 v[184:199], v[152:155], v[44:47], v[184:199]
    v_rcp_f32 v72, v72
    v_rcp_f32 v73, v73
    v_rcp_f32 v74, v74
    v_rcp_f32 v75, v75
    v_pk_mul_f32 v[72:73], v[164:165], v[72:73]
    v_pk_mul_f32 v[74:75], v[166:167], v[74:75]
    v_cvt_pk_bf16_f32 v162, v72, v73
    v_cvt_pk_bf16_f32 v163, v74, v75
    s_add_u32 s82, s82, 1
    s_nop 0
    v_mfma_f32_32x32x16_bf16 v[184:199], v[160:163], v[48:51], v[184:199]
    v_exp_f32 v68, v136
    v_exp_f32 v69, v137
    v_exp_f32 v70, v138
    v_exp_f32 v71, v139
    v_pk_add_f32 v[68:69], v[68:69], 1.0 op_sel_hi:[1,0]
    v_pk_add_f32 v[70:71], v[70:71], 1.0 op_sel_hi:[1,0]
    v_mfma_f32_32x32x16_bf16 v[152:167], v[40:43], v[124:127], 0
    v_rcp_f32 v68, v68
    v_rcp_f32 v69, v69
    v_rcp_f32 v70, v70
    v_rcp_f32 v71, v71
    v_pk_mul_f32 v[68:69], v[136:137], v[68:69]
    v_pk_mul_f32 v[70:71], v[138:139], v[70:71]
    v_cvt_pk_bf16_f32 v136, v68, v69
    v_cvt_pk_bf16_f32 v137, v70, v71
    s_mov_b64 exec, s[10:11]
    ds_write_b64 v15, v[18:19]
    s_mov_b64 exec, -1
    ds_read_b64_tr_b16 v[44:45], v8
    ds_read_b64_tr_b16 v[46:47], v8 offset:512
    ds_read_b64_tr_b16 v[48:49], v8 offset:1024
    ds_read_b64_tr_b16 v[50:51], v8 offset:1536
    s_mov_b64 exec, s[10:11]
    ds_write2_b32 v15, v0, v0 offset0:0 offset1:1
    s_mov_b64 exec, -1
    s_waitcnt lgkmcnt(6)
    v_and_b32 v14, 31, v14
    v_lshl_add_u32 v25, v14, 2, s72
    ds_read_b128 v[40:43], v25
    v_and_b32 v22, 0xffff0000, v16
    v_lshlrev_b32 v23, 16, v17
    v_and_b32 v24, 0xffff0000, v17
    v_mfma_f32_32x32x16_bf16 v[152:167], v[36:39], v[116:119], v[152:167]
    v_exp_f32 v72, v140
    v_exp_f32 v73, v141
    v_exp_f32 v74, v142
    v_exp_f32 v75, v143
    v_pk_add_f32 v[72:73], v[72:73], 1.0 op_sel_hi:[1,0]
    v_pk_add_f32 v[74:75], v[74:75], 1.0 op_sel_hi:[1,0]
    v_or_b32 v16, 0x3f80, v22
    v_mul_f32 v22, v22, v22
    v_mul_f32 v23, v23, v23
    v_mul_f32 v24, v24, v24
    s_add_u32 m0, s67, 32768
    v_mfma_f32_32x32x16_bf16 v[152:167], v[52:55], v[84:87], v[152:167]
    buffer_load_dwordx4 v28, s[16:19], s74 offen  lds
    v_rcp_f32 v72, v72
    v_rcp_f32 v73, v73
    v_rcp_f32 v74, v74
    v_rcp_f32 v75, v75
    v_pk_mul_f32 v[72:73], v[140:141], v[72:73]
    v_pk_mul_f32 v[74:75], v[142:143], v[74:75]
    v_cvt_pk_bf16_f32 v138, v72, v73
    v_cvt_pk_bf16_f32 v139, v74, v75
    v_cvt_pk_bf16_f32 v22, 0, v22
    v_cvt_pk_bf16_f32 v23, 0, v23
    v_cvt_pk_bf16_f32 v24, 0, v24
    v_lshl_add_u32 v14, v14, 1, v7
    s_add_u32 m0, s67, 33792
    v_mfma_f32_32x32x16_bf16 v[152:167], v[56:59], v[92:95], v[152:167]
    buffer_load_dwordx4 v29, s[16:19], s74 offen  lds
    v_exp_f32 v68, v144
    v_exp_f32 v69, v145
    v_exp_f32 v70, v146
    v_exp_f32 v71, v147
    v_pk_add_f32 v[68:69], v[68:69], 1.0 op_sel_hi:[1,0]
    v_pk_add_f32 v[70:71], v[70:71], 1.0 op_sel_hi:[1,0]
    s_sub_u32 s68, s82, 1
    s_cmp_lg_u32 s68, s80
    s_cbranch_scc1 L_noacc1
    v_swap_b32 v168, v200
    v_swap_b32 v169, v201
    v_swap_b32 v170, v202
    v_swap_b32 v171, v203
    v_swap_b32 v172, v204
    v_swap_b32 v173, v205
    v_swap_b32 v174, v206
    v_swap_b32 v175, v207
    v_swap_b32 v176, v208
    v_swap_b32 v177, v209
    v_swap_b32 v178, v210
    v_swap_b32 v179, v211
    v_swap_b32 v180, v212
    v_swap_b32 v181, v213
    v_swap_b32 v182, v214
    v_swap_b32 v183, v215
    v_swap_b32 v184, v216
    v_swap_b32 v185, v217
    v_swap_b32 v186, v218
    v_swap_b32 v187, v219
    v_swap_b32 v188, v220
    v_swap_b32 v189, v221
    v_swap_b32 v190, v222
    v_swap_b32 v191, v223
    v_swap_b32 v192, v224
    v_swap_b32 v193, v225
    v_swap_b32 v194, v226
    v_swap_b32 v195, v227
    v_swap_b32 v196, v228
    v_swap_b32 v197, v229
    v_swap_b32 v198, v230
    v_swap_b32 v199, v231
L_noacc1:
    v_add_f32 v22, v22, v23
    v_add_f32 v22, v22, v24
    v_cvt_pk_bf16_f32 v22, 0, v22
    s_waitcnt lgkmcnt(0)
    v_or_b32 v43, v43, v22
    s_add_u32 m0, s67, 34816
    v_mfma_f32_32x32x16_bf16 v[152:167], v[60:63], v[100:103], v[152:167]
    buffer_load_dwordx4 v30, s[16:19], s74 offen  lds
    v_rcp_f32 v68, v68
    v_rcp_f32 v69, v69
    v_rcp_f32 v70, v70
    v_rcp_f32 v71, v71
    v_pk_mul_f32 v[68:69], v[144:145], v[68:69]
    v_pk_mul_f32 v[70:71], v[146:147], v[70:71]
    v_cvt_pk_bf16_f32 v144, v68, v69
    v_cvt_pk_bf16_f32 v145, v70, v71
    s_add_u32 m0, s67, 35840
    v_mfma_f32_32x32x16_bf16 v[152:167], v[64:67], v[108:111], v[152:167]
    buffer_load_dwordx4 v31, s[16:19], s74 offen  lds
    v_exp_f32 v72, v148
    v_exp_f32 v73, v149
    v_exp_f32 v74, v150
    v_exp_f32 v75, v151
    v_pk_add_f32 v[72:73], v[72:73], 1.0 op_sel_hi:[1,0]
    v_pk_add_f32 v[74:75], v[74:75], 1.0 op_sel_hi:[1,0]
    s_sub_u32 s68, s66, s82
    s_cmp_gt_u32 s68, 3
    s_cbranch_scc1 L_pr1
    s_setprio 2
    s_cmp_gt_u32 s68, 1
    s_cbranch_scc1 L_pr1
    s_setprio 1
    s_cmp_gt_u32 s68, 0
    s_cbranch_scc1 L_pr1
    s_setprio 0
L_pr1:
    s_waitcnt vmcnt(5)
    ds_read_b128 v[52:55], v3 offset:0
    ds_read_b128 v[56:59], v4 offset:0
    ds_read_b128 v[60:63], v5 offset:0
    ds_read_b128 v[64:67], v6 offset:0
    v_mfma_f32_32x32x16_bf16 v[168:183], v[136:139], v[44:47], v[168:183]
    v_rcp_f32 v72, v72
    v_rcp_f32 v73, v73
    v_rcp_f32 v74, v74
    v_rcp_f32 v75, v75
    v_pk_mul_f32 v[72:73], v[148:149], v[72:73]
    v_pk_mul_f32 v[74:75], v[150:151], v[74:75]
    v_cvt_pk_bf16_f32 v146, v72, v73
    v_cvt_pk_bf16_f32 v147, v74, v75
    s_cmp_lg_u32 s82, s66
    s_cbranch_scc1 L_tile
L_tail:
    s_waitcnt vmcnt(0) lgkmcnt(0)
    s_sub_u32 s4, s79, s78
    s_add_u32 s69, s61, s78
    v_lshrrev_b32 v20, 1, v9
    buffer_load_dwordx2 v[96:97], v20, s[40:43], 0 offen offset:0
    buffer_load_dwordx2 v[98:99], v20, s[40:43], 0 offen offset:16
    buffer_load_dwordx2 v[100:101], v20, s[40:43], 0 offen offset:32
    buffer_load_dwordx2 v[102:103], v20, s[40:43], 0 offen offset:48
    buffer_load_dwordx2 v[104:105], v20, s[40:43], 0 offen offset:64
    buffer_load_dwordx2 v[106:107], v20, s[40:43], 0 offen offset:80
    buffer_load_dwordx2 v[108:109], v20, s[40:43], 0 offen offset:96
    buffer_load_dwordx2 v[110:111], v20, s[40:43], 0 offen offset:112
    v_bfe_u32 v22, v12, 2, 3
    v_and_b32 v21, 1, v12
    v_lshl_add_u32 v20, v22, 4, s69
    v_mad_i32_i24 v20, v21, s4, v20
    v_lshl_add_u32 v20, v20, 7, v9
    buffer_load_dwordx4 v[52:55], v20, s[16:19], 0 offen offset:0
    buffer_load_dwordx4 v[56:59], v20, s[16:19], 0 offen offset:32
    buffer_load_dwordx4 v[60:63], v20, s[16:19], 0 offen offset:64
    buffer_load_dwordx4 v[64:67], v20, s[16:19], 0 offen offset:96
    v_mov_b32 v23, 2147483616
    v_lshrrev_b32 v21, 4, v9
    v_lshl_add_u32 v22, v22, 4, s78
    v_mad_i32_i24 v22, v21, s4, v22
    v_and_b32 v21, 3, v12
    v_cmp_gt_u32 vcc, s62, v22
    v_cmp_ne_u32 s[6:7], 0, v21
    v_mad_u32_u24 v22, v22, 6, s76
    v_lshl_add_u32 v22, v21, 1, v22
    s_and_b64 vcc, vcc, s[6:7]
    v_add_u32 v22, -2, v22
    v_cndmask_b32 v30, v23, v22, vcc
    buffer_load_short_d16_hi v31, v30, s[20:23], 0 offen
    v_and_b32 v22, 31, v12
    v_add_u32 v24, s78, v9
    v_add_u32 v26, s61, v24
    v_lshlrev_b32 v26, 7, v26
    v_lshl_add_u32 v26, v22, 1, v26
    v_add_u32 v27, 0, v24
    v_cmp_gt_u32 vcc, s62, v27
    v_add_u32 v27, 0, v26
    s_nop 0
    v_cndmask_b32 v32, v23, v27, vcc
    buffer_load_short_d16_hi v80, v32, s[16:19], 0 offen offset:0
    buffer_load_short_d16_hi v81, v32, s[16:19], 0 offen offset:64
    v_add_u32 v27, 32, v24
    v_cmp_gt_u32 vcc, s62, v27
    v_add_u32 v27, 4096, v26
    s_nop 0
    v_cndmask_b32 v33, v23, v27, vcc
    buffer_load_short_d16_hi v82, v33, s[16:19], 0 offen offset:0
    buffer_load_short_d16_hi v83, v33, s[16:19], 0 offen offset:64
    v_add_u32 v27, 64, v24
    v_cmp_gt_u32 vcc, s62, v27
    v_add_u32 v27, 8192, v26
    s_nop 0
    v_cndmask_b32 v34, v23, v27, vcc
    buffer_load_short_d16_hi v84, v34, s[16:19], 0 offen offset:0
    buffer_load_short_d16_hi v85, v34, s[16:19], 0 offen offset:64
    v_add_u32 v27, 96, v24
    v_cmp_gt_u32 vcc, s62, v27
    v_add_u32 v27, 12288, v26
    s_nop 0
    v_cndmask_b32 v35, v23, v27, vcc
    buffer_load_short_d16_hi v86, v35, s[16:19], 0 offen offset:0
    buffer_load_short_d16_hi v87, v35, s[16:19], 0 offen offset:64
    v_add_u32 v24, s79, v9
    v_add_u32 v26, s61, v24
    v_lshlrev_b32 v26, 7, v26
    v_lshl_add_u32 v26, v22, 1, v26
    v_add_u32 v27, 0, v24
    v_cmp_gt_u32 vcc, s62, v27
    v_add_u32 v27, 0, v26
    s_nop 0
    v_cndmask_b32 v36, v23, v27, vcc
    buffer_load_short_d16_hi v88, v36, s[16:19], 0 offen offset:0
    buffer_load_short_d16_hi v89, v36, s[16:19], 0 offen offset:64
    v_add_u32 v27, 32, v24
    v_cmp_gt_u32 vcc, s62, v27
    v_add_u32 v27, 4096, v26
    s_nop 0
    v_cndmask_b32 v37, v23, v27, vcc
    buffer_load_short_d16_hi v90, v37, s[16:19], 0 offen offset:0
    buffer_load_short_d16_hi v91, v37, s[16:19], 0 offen offset:64
    v_add_u32 v27, 64, v24
    v_cmp_gt_u32 vcc, s62, v27
    v_add_u32 v27, 8192, v26
    s_nop 0
    v_cndmask_b32 v38, v23, v27, vcc
    buffer_load_short_d16_hi v92, v38, s[16:19], 0 offen offset:0
    buffer_load_short_d16_hi v93, v38, s[16:19], 0 offen offset:64
    v_add_u32 v27, 96, v24
    v_cmp_gt_u32 vcc, s62, v27
    v_add_u32 v27, 12288, v26
    s_nop 0
    v_cndmask_b32 v39, v23, v27, vcc
    buffer_load_short_d16_hi v94, v39, s[16:19], 0 offen offset:0
    buffer_load_short_d16_hi v95, v39, s[16:19], 0 offen offset:64
    s_cmp_eq_u32 s66, 0
    s_cbranch_scc1 L_tilesdone
    v_mfma_f32_32x32x16_bf16 v[168:183], v[144:147], v[48:51], v[168:183]
    v_exp_f32 v68, v152
    v_exp_f32 v69, v153
    v_exp_f32 v70, v154
    v_exp_f32 v71, v155
    v_pk_add_f32 v[68:69], v[68:69], 1.0 op_sel_hi:[1,0]
    v_pk_add_f32 v[70:71], v[70:71], 1.0 op_sel_hi:[1,0]
    v_rcp_f32 v68, v68
    v_rcp_f32 v69, v69
    v_rcp_f32 v70, v70
    v_rcp_f32 v71, v71
    v_pk_mul_f32 v[68:69], v[152:153], v[68:69]
    v_pk_mul_f32 v[70:71], v[154:155], v[70:71]
    v_cvt_pk_bf16_f32 v152, v68, v69
    v_cvt_pk_bf16_f32 v153, v70, v71
    v_exp_f32 v72, v156
    v_exp_f32 v73, v157
    v_exp_f32 v74, v158
    v_exp_f32 v75, v159
    v_pk_add_f32 v[72:73], v[72:73], 1.0 op_sel_hi:[1,0]
    v_pk_add_f32 v[74:75], v[74:75], 1.0 op_sel_hi:[1,0]
    v_rcp_f32 v72, v72
    v_rcp_f32 v73, v73
    v_rcp_f32 v74, v74
    v_rcp_f32 v75, v75
    v_pk_mul_f32 v[72:73], v[156:157], v[72:73]
    v_pk_mul_f32 v[74:75], v[158:159], v[74:75]
    v_cvt_pk_bf16_f32 v154, v72, v73
    v_cvt_pk_bf16_f32 v155, v74, v75
    v_exp_f32 v68, v160
    v_exp_f32 v69, v161
    v_exp_f32 v70, v162
    v_exp_f32 v71, v163
    v_pk_add_f32 v[68:69], v[68:69], 1.0 op_sel_hi:[1,0]
    v_pk_add_f32 v[70:71], v[70:71], 1.0 op_sel_hi:[1,0]
    v_rcp_f32 v68, v68
    v_rcp_f32 v69, v69
    v_rcp_f32 v70, v70
    v_rcp_f32 v71, v71
    v_pk_mul_f32 v[68:69], v[160:161], v[68:69]
    v_pk_mul_f32 v[70:71], v[162:163], v[70:71]
    v_cvt_pk_bf16_f32 v160, v68, v69
    v_cvt_pk_bf16_f32 v161, v70, v71
    v_exp_f32 v72, v164
    v_exp_f32 v73, v165
    v_exp_f32 v74, v166
    v_exp_f32 v75, v167
    v_pk_add_f32 v[72:73], v[72:73], 1.0 op_sel_hi:[1,0]
    v_pk_add_f32 v[74:75], v[74:75], 1.0 op_sel_hi:[1,0]
    v_mfma_f32_32x32x16_bf16 v[184:199], v[152:155], v[44:47], v[184:199]
    v_rcp_f32 v72, v72
    v_rcp_f32 v73, v73
    v_rcp_f32 v74, v74
    v_rcp_f32 v75, v75
    v_pk_mul_f32 v[72:73], v[164:165], v[72:73]
    v_pk_mul_f32 v[74:75], v[166:167], v[74:75]
    v_cvt_pk_bf16_f32 v162, v72, v73
    v_cvt_pk_bf16_f32 v163, v74, v75
    s_cmp_eq_u32 s80, s66
    s_nop 0
    v_mfma_f32_32x32x16_bf16 v[184:199], v[160:163], v[48:51], v[184:199]
    s_cbranch_scc1 L_tilesdone
    v_swap_b32 v168, v200
    v_swap_b32 v169, v201
    v_swap_b32 v170, v202
    v_swap_b32 v171, v203
    v_swap_b32 v172, v204
    v_swap_b32 v173, v205
    v_swap_b32 v174, v206
    v_swap_b32 v175, v207
    v_swap_b32 v176, v208
    v_swap_b32 v177, v209
    v_swap_b32 v178, v210
    v_swap_b32 v179, v211
    v_swap_b32 v180, v212
    v_swap_b32 v181, v213
    v_swap_b32 v182, v214
    v_swap_b32 v183, v215
    v_swap_b32 v184, v216
    v_swap_b32 v185, v217
    v_swap_b32 v186, v218
    v_swap_b32 v187, v219
    v_swap_b32 v188, v220
    v_swap_b32 v189, v221
    v_swap_b32 v190, v222
    v_swap_b32 v191, v223
    v_swap_b32 v192, v224
    v_swap_b32 v193, v225
    v_swap_b32 v194, v226
    v_swap_b32 v195, v227
    v_swap_b32 v196, v228
    v_swap_b32 v197, v229
    v_swap_b32 v198, v230
    v_swap_b32 v199, v231
L_tilesdone:
    s_cmp_eq_u32 s64, 256
    s_cbranch_scc1 L_epi
    s_add_u32 s65, s65, 32
    s_waitcnt vmcnt(0)
    s_cmp_lg_u32 s73, 0
    s_cbranch_scc1 L_batch
    s_mov_b32 s65, 0
    s_add_u32 s63, s63, 8
    s_cmp_lt_u32 s63, 256
    s_cbranch_scc1 L_batch
L_epi:
    v_add_u32 v20, 132096, v76
    v_lshlrev_b32 v21, 5, v9
    v_sub_u32 v21, v20, v21
    ds_read_b64_tr_b16 v[40:41], v20 offset:0
    ds_read_b64_tr_b16 v[42:43], v20 offset:512
    ds_read_b64_tr_b16 v[44:45], v20 offset:64
    ds_read_b64_tr_b16 v[46:47], v20 offset:576
    ds_read_b64_tr_b16 v[48:49], v20 offset:2048
    ds_read_b64_tr_b16 v[50:51], v20 offset:2560
    s_mov_b32 s68, 0xbf317218
    s_nop 3
    s_waitcnt vmcnt(17)
    ds_read_b64_tr_b16 v[68:69], v20 offset:2112
    ds_read_b64_tr_b16 v[70:71], v20 offset:2624
    s_waitcnt lgkmcnt(6)
    v_mfma_f32_32x32x16_bf16 v[136:151], v[52:55], v[40:43], 0
    v_mul_f32 v168, s68, v168
    v_mul_f32 v169, s68, v169
    v_cvt_pk_bf16_f32 v168, v168, v169
    v_mul_f32 v170, s68, v170
    v_mul_f32 v171, s68, v171
    v_cvt_pk_bf16_f32 v169, v170, v171
    v_mul_f32 v172, s68, v172
    v_mul_f32 v173, s68, v173
    v_cvt_pk_bf16_f32 v170, v172, v173
    v_mul_f32 v174, s68, v174
    v_mul_f32 v175, s68, v175
    v_cvt_pk_bf16_f32 v171, v174, v175
    ds_read_b64_tr_b16 v[40:41], v20 offset:4096
    ds_read_b64_tr_b16 v[42:43], v20 offset:4608
    s_waitcnt lgkmcnt(6)
    v_mfma_f32_32x32x16_bf16 v[152:167], v[52:55], v[44:47], 0
    v_mul_f32 v176, s68, v176
    v_mul_f32 v177, s68, v177
    v_cvt_pk_bf16_f32 v172, v176, v177
    v_mul_f32 v178, s68, v178
    v_mul_f32 v179, s68, v179
    v_cvt_pk_bf16_f32 v173, v178, v179
    v_mul_f32 v180, s68, v180
    v_mul_f32 v181, s68, v181
    v_cvt_pk_bf16_f32 v174, v180, v181
    v_mul_f32 v182, s68, v182
    v_mul_f32 v183, s68, v183
    v_cvt_pk_bf16_f32 v175, v182, v183
    ds_read_b64_tr_b16 v[44:45], v20 offset:4160
    ds_read_b64_tr_b16 v[46:47], v20 offset:4672
    s_waitcnt lgkmcnt(6)
    v_mfma_f32_32x32x16_bf16 v[136:151], v[56:59], v[48:51], v[136:151]
    v_mul_f32 v184, s68, v184
    v_mul_f32 v185, s68, v185
    v_cvt_pk_bf16_f32 v184, v184, v185
    v_mul_f32 v186, s68, v186
    v_mul_f32 v187, s68, v187
    v_cvt_pk_bf16_f32 v185, v186, v187
    v_mul_f32 v188, s68, v188
    v_mul_f32 v189, s68, v189
    v_cvt_pk_bf16_f32 v186, v188, v189
    v_mul_f32 v190, s68, v190
    v_mul_f32 v191, s68, v191
    v_cvt_pk_bf16_f32 v187, v190, v191
    ds_read_b64_tr_b16 v[48:49], v20 offset:6144
    ds_read_b64_tr_b16 v[50:51], v20 offset:6656
    s_waitcnt lgkmcnt(6)
    v_mfma_f32_32x32x16_bf16 v[152:167], v[56:59], v[68:71], v[152:167]
    v_mul_f32 v192, s68, v192
    v_mul_f32 v193, s68, v193
    v_cvt_pk_bf16_f32 v188, v192, v193
    v_mul_f32 v194, s68, v194
    v_mul_f32 v195, s68, v195
    v_cvt_pk_bf16_f32 v189, v194, v195
    v_mul_f32 v196, s68, v196
    v_mul_f32 v197, s68, v197
    v_cvt_pk_bf16_f32 v190, v196, v197
    v_mul_f32 v198, s68, v198
    v_mul_f32 v199, s68, v199
    v_cvt_pk_bf16_f32 v191, v198, v199
    ds_read_b64_tr_b16 v[68:69], v20 offset:6208
    ds_read_b64_tr_b16 v[70:71], v20 offset:6720
    s_waitcnt lgkmcnt(6)
    v_mfma_f32_32x32x16_bf16 v[136:151], v[60:63], v[40:43], v[136:151]
    v_mul_f32 v200, s68, v200
    v_mul_f32 v201, s68, v201
    v_cvt_pk_bf16_f32 v200, v200, v201
    v_mul_f32 v202, s68, v202
    v_mul_f32 v203, s68, v203
    v_cvt_pk_bf16_f32 v201, v202, v203
    v_mul_f32 v204, s68, v204
    v_mul_f32 v205, s68, v205
    v_cvt_pk_bf16_f32 v202, v204, v205
    v_mul_f32 v206, s68, v206
    v_mul_f32 v207, s68, v207
    v_cvt_pk_bf16_f32 v203, v206, v207
    ds_read_b64_tr_b16 v[40:41], v21 offset:8192
    ds_read_b64_tr_b16 v[42:43], v21 offset:9216
    s_waitcnt lgkmcnt(6)
    v_mfma_f32_32x32x16_bf16 v[152:167], v[60:63], v[44:47], v[152:167]
    v_mul_f32 v208, s68, v208
    v_mul_f32 v209, s68, v209
    v_cvt_pk_bf16_f32 v204, v208, v209
    v_mul_f32 v210, s68, v210
    v_mul_f32 v211, s68, v211
    v_cvt_pk_bf16_f32 v205, v210, v211
    v_mul_f32 v212, s68, v212
    v_mul_f32 v213, s68, v213
    v_cvt_pk_bf16_f32 v206, v212, v213
    v_mul_f32 v214, s68, v214
    v_mul_f32 v215, s68, v215
    v_cvt_pk_bf16_f32 v207, v214, v215
    ds_read_b64_tr_b16 v[44:45], v21 offset:8256
    ds_read_b64_tr_b16 v[46:47], v21 offset:9280
    s_waitcnt lgkmcnt(6)
    v_mfma_f32_32x32x16_bf16 v[136:151], v[64:67], v[48:51], v[136:151]
    v_mul_f32 v216, s68, v216
    v_mul_f32 v217, s68, v217
    v_cvt_pk_bf16_f32 v216, v216, v217
    v_mul_f32 v218, s68, v218
    v_mul_f32 v219, s68, v219
    v_cvt_pk_bf16_f32 v217, v218, v219
    v_mul_f32 v220, s68, v220
    v_mul_f32 v221, s68, v221
    v_cvt_pk_bf16_f32 v218, v220, v221
    v_mul_f32 v222, s68, v222
    v_mul_f32 v223, s68, v223
    v_cvt_pk_bf16_f32 v219, v222, v223
    ds_read_b64_tr_b16 v[48:49], v21 offset:10240
    ds_read_b64_tr_b16 v[50:51], v21 offset:11264
    s_waitcnt lgkmcnt(6)
    v_mfma_f32_32x32x16_bf16 v[152:167], v[64:67], v[68:71], v[152:167]
    v_mul_f32 v224, s68, v224
    v_mul_f32 v225, s68, v225
    v_cvt_pk_bf16_f32 v220, v224, v225
    v_mul_f32 v226, s68, v226
    v_mul_f32 v227, s68, v227
    v_cvt_pk_bf16_f32 v221, v226, v227
    v_mul_f32 v228, s68, v228
    v_mul_f32 v229, s68, v229
    v_cvt_pk_bf16_f32 v222, v228, v229
    v_mul_f32 v230, s68, v230
    v_mul_f32 v231, s68, v231
    v_cvt_pk_bf16_f32 v223, v230, v231
    v_mfma_f32_32x32x16_bf16 v[112:127], v[96:99], v[168:171], 0
    v_mfma_f32_32x32x16_bf16 v[232:247], v[96:99], v[200:203], 0
    v_mfma_f32_32x32x16_bf16 v[112:127], v[100:103], v[172:175], v[112:127]
    v_mfma_f32_32x32x16_bf16 v[232:247], v[100:103], v[204:207], v[232:247]
    v_mfma_f32_32x32x16_bf16 v[112:127], v[104:107], v[184:187], v[112:127]
    v_mfma_f32_32x32x16_bf16 v[232:247], v[104:107], v[216:219], v[232:247]
    v_mfma_f32_32x32x16_bf16 v[112:127], v[108:111], v[188:191], v[112:127]
    v_mfma_f32_32x32x16_bf16 v[232:247], v[108:111], v[220:223], v[232:247]
    s_mov_b32 vcc_lo, 0xdddddddd
    s_mov_b32 vcc_hi, 0xdddddddd
    v_cndmask_b32_dpp v168, v200, v168, vcc quad_perm:[0,0,0,0] row_mask:0xf bank_mask:0xf
    v_cndmask_b32_dpp v169, v201, v169, vcc quad_perm:[0,0,0,0] row_mask:0xf bank_mask:0xf
    v_cndmask_b32_dpp v170, v202, v170, vcc quad_perm:[0,0,0,0] row_mask:0xf bank_mask:0xf
    v_cndmask_b32_dpp v171, v203, v171, vcc quad_perm:[0,0,0,0] row_mask:0xf bank_mask:0xf
    v_cndmask_b32_dpp v172, v204, v172, vcc quad_perm:[0,0,0,0] row_mask:0xf bank_mask:0xf
    v_cndmask_b32_dpp v173, v205, v173, vcc quad_perm:[0,0,0,0] row_mask:0xf bank_mask:0xf
    v_cndmask_b32_dpp v174, v206, v174, vcc quad_perm:[0,0,0,0] row_mask:0xf bank_mask:0xf
    v_cndmask_b32_dpp v175, v207, v175, vcc quad_perm:[0,0,0,0] row_mask:0xf bank_mask:0xf
    v_cndmask_b32_dpp v184, v216, v184, vcc quad_perm:[0,0,0,0] row_mask:0xf bank_mask:0xf
    v_cndmask_b32_dpp v185, v217, v185, vcc quad_perm:[0,0,0,0] row_mask:0xf bank_mask:0xf
    v_cndmask_b32_dpp v186, v218, v186, vcc quad_perm:[0,0,0,0] row_mask:0xf bank_mask:0xf
    v_cndmask_b32_dpp v187, v219, v187, vcc quad_perm:[0,0,0,0] row_mask:0xf bank_mask:0xf
    v_cndmask_b32_dpp v188, v220, v188, vcc quad_perm:[0,0,0,0] row_mask:0xf bank_mask:0xf
    v_cndmask_b32_dpp v189, v221, v189, vcc quad_perm:[0,0,0,0] row_mask:0xf bank_mask:0xf
    v_cndmask_b32_dpp v190, v222, v190, vcc quad_perm:[0,0,0,0] row_mask:0xf bank_mask:0xf
    v_cndmask_b32_dpp v191, v223, v191, vcc quad_perm:[0,0,0,0] row_mask:0xf bank_mask:0xf
    ds_read_b64_tr_b16 v[68:69], v21 offset:10304
    ds_read_b64_tr_b16 v[70:71], v21 offset:11328
    s_waitcnt lgkmcnt(6)
    v_mfma_f32_32x32x16_bf16 v[136:151], v[168:171], v[40:43], v[136:151]
    ds_read_b64_tr_b16 v[40:41], v21 offset:12288
    ds_read_b64_tr_b16 v[42:43], v21 offset:13312
    s_waitcnt lgkmcnt(6)
    v_mfma_f32_32x32x16_bf16 v[152:167], v[168:171], v[44:47], v[152:167]
    ds_read_b64_tr_b16 v[44:45], v21 offset:12352
    ds_read_b64_tr_b16 v[46:47], v21 offset:13376
    s_waitcnt lgkmcnt(6)
    v_mfma_f32_32x32x16_bf16 v[136:151], v[172:175], v[48:51], v[136:151]
    ds_read_b64_tr_b16 v[48:49], v21 offset:14336
    ds_read_b64_tr_b16 v[50:51], v21 offset:15360
    s_waitcnt lgkmcnt(6)
    v_mfma_f32_32x32x16_bf16 v[152:167], v[172:175], v[68:71], v[152:167]
    ds_read_b64_tr_b16 v[68:69], v21 offset:14400
    ds_read_b64_tr_b16 v[70:71], v21 offset:15424
    s_waitcnt lgkmcnt(6)
    v_mfma_f32_32x32x16_bf16 v[136:151], v[184:187], v[40:43], v[136:151]
    s_waitcnt lgkmcnt(4)
    v_mfma_f32_32x32x16_bf16 v[152:167], v[184:187], v[44:47], v[152:167]
    s_waitcnt lgkmcnt(2)
    v_mfma_f32_32x32x16_bf16 v[136:151], v[188:191], v[48:51], v[136:151]
    s_waitcnt lgkmcnt(0)
    v_mfma_f32_32x32x16_bf16 v[152:167], v[188:191], v[68:71], v[152:167]
    v_cndmask_b32 v28, v112, v232, s[8:9]
    s_waitcnt vmcnt(0)
    v_add_f32 v28, v28, v31
    v_cvt_pk_bf16_f32 v28, v28, v28
    s_mov_b32 s68, 3200000
    buffer_store_short v28, v30, s[32:35], s68 offen
    s_nop 5
    v_mul_f32 v40, s75, v136
    v_mul_f32 v41, s75, v152
    v_mul_f32 v42, s75, v140
    v_mul_f32 v43, s75, v156
    v_mul_f32 v44, s75, v144
    v_mul_f32 v45, s75, v160
    v_mul_f32 v46, s75, v148
    v_mul_f32 v47, s75, v164
    v_exp_f32 v40, v40
    v_exp_f32 v41, v41
    v_exp_f32 v42, v42
    v_exp_f32 v43, v43
    v_exp_f32 v44, v44
    v_exp_f32 v45, v45
    v_exp_f32 v46, v46
    v_exp_f32 v47, v47
    v_add_f32 v40, 1.0, v40
    v_add_f32 v41, 1.0, v41
    v_add_f32 v42, 1.0, v42
    v_add_f32 v43, 1.0, v43
    v_add_f32 v44, 1.0, v44
    v_add_f32 v45, 1.0, v45
    v_add_f32 v46, 1.0, v46
    v_add_f32 v47, 1.0, v47
    v_rcp_f32 v40, v40
    v_rcp_f32 v41, v41
    v_rcp_f32 v42, v42
    v_rcp_f32 v43, v43
    v_rcp_f32 v44, v44
    v_rcp_f32 v45, v45
    v_rcp_f32 v46, v46
    v_rcp_f32 v47, v47
    v_fma_f32 v80, v136, v40, v80
    v_fma_f32 v81, v152, v41, v81
    v_fma_f32 v82, v140, v42, v82
    v_fma_f32 v83, v156, v43, v83
    v_fma_f32 v84, v144, v44, v84
    v_fma_f32 v85, v160, v45, v85
    v_fma_f32 v86, v148, v46, v86
    v_fma_f32 v87, v164, v47, v87
    v_cvt_pk_bf16_f32 v80, v80, v80
    v_cvt_pk_bf16_f32 v81, v81, v81
    v_cvt_pk_bf16_f32 v82, v82, v82
    v_cvt_pk_bf16_f32 v83, v83, v83
    v_cvt_pk_bf16_f32 v84, v84, v84
    v_cvt_pk_bf16_f32 v85, v85, v85
    v_cvt_pk_bf16_f32 v86, v86, v86
    v_cvt_pk_bf16_f32 v87, v87, v87
    buffer_store_short v80, v32, s[32:35], 0 offen offset:0
    buffer_store_short v81, v32, s[32:35], 0 offen offset:64
    buffer_store_short v82, v33, s[32:35], 0 offen offset:0
    buffer_store_short v83, v33, s[32:35], 0 offen offset:64
    buffer_store_short v84, v34, s[32:35], 0 offen offset:0
    buffer_store_short v85, v34, s[32:35], 0 offen offset:64
    buffer_store_short v86, v35, s[32:35], 0 offen offset:0
    buffer_store_short v87, v35, s[32:35], 0 offen offset:64
    v_mul_f32 v48, s75, v137
    v_mul_f32 v49, s75, v153
    v_mul_f32 v50, s75, v141
    v_mul_f32 v51, s75, v157
    v_mul_f32 v52, s75, v145
    v_mul_f32 v53, s75, v161
    v_mul_f32 v54, s75, v149
    v_mul_f32 v55, s75, v165
    v_exp_f32 v48, v48
    v_exp_f32 v49, v49
    v_exp_f32 v50, v50
    v_exp_f32 v51, v51
    v_exp_f32 v52, v52
    v_exp_f32 v53, v53
    v_exp_f32 v54, v54
    v_exp_f32 v55, v55
    v_add_f32 v48, 1.0, v48
    v_add_f32 v49, 1.0, v49
    v_add_f32 v50, 1.0, v50
    v_add_f32 v51, 1.0, v51
    v_add_f32 v52, 1.0, v52
    v_add_f32 v53, 1.0, v53
    v_add_f32 v54, 1.0, v54
    v_add_f32 v55, 1.0, v55
    v_rcp_f32 v48, v48
    v_rcp_f32 v49, v49
    v_rcp_f32 v50, v50
    v_rcp_f32 v51, v51
    v_rcp_f32 v52, v52
    v_rcp_f32 v53, v53
    v_rcp_f32 v54, v54
    v_rcp_f32 v55, v55
    v_fma_f32 v88, v137, v48, v88
    v_fma_f32 v89, v153, v49, v89
    v_fma_f32 v90, v141, v50, v90
    v_fma_f32 v91, v157, v51, v91
    v_fma_f32 v92, v145, v52, v92
    v_fma_f32 v93, v161, v53, v93
    v_fma_f32 v94, v149, v54, v94
    v_fma_f32 v95, v165, v55, v95
    v_cvt_pk_bf16_f32 v88, v88, v88
    v_cvt_pk_bf16_f32 v89, v89, v89
    v_cvt_pk_bf16_f32 v90, v90, v90
    v_cvt_pk_bf16_f32 v91, v91, v91
    v_cvt_pk_bf16_f32 v92, v92, v92
    v_cvt_pk_bf16_f32 v93, v93, v93
    v_cvt_pk_bf16_f32 v94, v94, v94
    v_cvt_pk_bf16_f32 v95, v95, v95
    buffer_store_short v88, v36, s[32:35], 0 offen offset:0
    buffer_store_short v89, v36, s[32:35], 0 offen offset:64
    buffer_store_short v90, v37, s[32:35], 0 offen offset:0
    buffer_store_short v91, v37, s[32:35], 0 offen offset:64
    buffer_store_short v92, v38, s[32:35], 0 offen offset:0
    buffer_store_short v93, v38, s[32:35], 0 offen offset:64
    buffer_store_short v94, v39, s[32:35], 0 offen offset:0
    buffer_store_short v95, v39, s[32:35], 0 offen offset:64
L_end:
    s_endpgm
.section .rodata,"a"
.p2align 6
.amdhsa_kernel gather_scatter__cheap_equivariant_egnn__graph_kernel
  .amdhsa_next_free_vgpr 256
  .amdhsa_next_free_sgpr 88
  .amdhsa_accum_offset 256
  .amdhsa_group_segment_fixed_size 0
  .amdhsa_kernarg_size 88
  .amdhsa_user_sgpr_count 2
  .amdhsa_user_sgpr_kernarg_segment_ptr 1
  .amdhsa_system_sgpr_workgroup_id_x 1
  .amdhsa_float_denorm_mode_32 3
.end_amdhsa_kernel
```
